```python
import torch

def _softmax(x, axis=-1):
    return torch.softmax(x, dim=axis)
def _gelu(x):
    return torch.nn.functional.gelu(x, approximate="tanh")
def _silu(x):
    return torch.nn.functional.silu(x)
def _sigmoid(x):
    return torch.sigmoid(x)
def _layernorm(x, axis=-1, eps=1e-5):
    m = x.mean(dim=axis, keepdim=True)
    v = x.var(dim=axis, keepdim=True, unbiased=False)
    return (x - m) / torch.sqrt(v + eps)
def _scatter_add(tgt, idx, src, axis=0):
    return tgt.clone().index_add_(axis, idx, src)
def _segment_sum(src, seg, n):
    out = torch.zeros((n,) + src.shape[1:], dtype=src.dtype)
    return out.index_add_(0, seg, src)
def _pad(x, pw):
    flat = tuple(v for pair in reversed(pw) for v in pair)
    return torch.nn.functional.pad(x, flat)

kernel_name = 'parallel_sum__gqa_block_cached__glu_gated_bilinear__decode'

def setup_inputs():

    _w = (lambda a: (lambda t: t.to(torch.bfloat16) if t.is_floating_point() else t)(torch.as_tensor(a)))
    def _A_setup():
        B, Sq, D = 8, 1, 1024
        Hq, Hkv, Sk, Dh = 32, 4, 4096, 128
        assert Hq % Hkv == 0, (Hq, Hkv)
        return {
            "x": _w((lambda *s: torch.randn(*s, dtype=torch.bfloat16) * 0.05)(B, Sq, D)),
            "k_cache": _w((lambda *s: torch.randn(*s, dtype=torch.bfloat16) * 1.6)(B, Hkv, Sk, Dh)),
            "v_cache": _w((lambda *s: torch.randn(*s, dtype=torch.bfloat16) * 0.8)(B, Hkv, Sk, Dh)),
            "wq": _w((lambda *s: torch.randn(*s, dtype=torch.bfloat16) * 1.6)(D, Hq * Dh) * (D ** -0.5)),
            "wo": _w((lambda *s: torch.randn(*s, dtype=torch.bfloat16) * 0.8)(Hq * Dh, D) * ((Hq * Dh) ** -0.5)),
        }
    _A_in = _A_setup()

    def _B_setup():
        B, S, D, F = 8, 1, 1024, 3584
        return {
            "x": _w((lambda *s: torch.randn(*s, dtype=torch.bfloat16) * 0.05)(B, S, D)),
            "w_gate": _w((lambda *s: torch.randn(*s, dtype=torch.bfloat16) * 0.4)(D, F) * (D ** -0.5)),
            "w_up": _w((lambda *s: torch.randn(*s, dtype=torch.bfloat16) * 0.4)(D, F) * (D ** -0.5)),
            "w_down": _w((lambda *s: torch.randn(*s, dtype=torch.bfloat16) * 0.4)(F, D) * (F ** -0.5)),
        }
    _B_in = _B_setup()

    return {
        "A_x": _A_in["x"],
        "A_k_cache": _A_in["k_cache"],
        "A_v_cache": _A_in["v_cache"],
        "A_wq": _A_in["wq"],
        "A_wo": _A_in["wo"],
        "B_x": _B_in["x"],
        "B_w_gate": _B_in["w_gate"],
        "B_w_up": _B_in["w_up"],
        "B_w_down": _B_in["w_down"],
    }

def reference(A_x, A_k_cache, A_v_cache, A_wq, A_wo, B_x, B_w_gate, B_w_up, B_w_down):
    def _A_ref(x, k_cache, v_cache, wq, wo):
        B, Sq, D = x.shape
        Hq, Dh = 32, 128
        Hkv = k_cache.shape[1]
        rep = Hq // Hkv
        q = (lambda x, *d: x.permute(*d))((x @ wq).reshape(B, Sq, Hq, Dh), 0, 2, 1, 3)
        k = (lambda x, n, axis: torch.repeat_interleave(x, n, dim=axis))(k_cache, rep, axis=1)
        v = (lambda x, n, axis: torch.repeat_interleave(x, n, dim=axis))(v_cache, rep, axis=1)
        scores = torch.einsum("bhqd,bhkd->bhqk", q, k) * (Dh ** -0.5)
        p = _softmax(scores, axis=-1)
        o = torch.einsum("bhqk,bhkd->bhqd", p, v)
        return (lambda x, *d: x.permute(*d))(o, 0, 2, 1, 3).reshape(B, Sq, Hq * Dh) @ wo

    def _B_ref(x, w_gate, w_up, w_down):
        g = torch.einsum("bsd,df->bsf", x, w_gate)
        u = torch.einsum("bsd,df->bsf", x, w_up)
        h = g * u
        return torch.einsum("bsf,fd->bsd", h, w_down)

    x = A_x
    xn = _layernorm(x, axis=-1)
    return x + _A_ref(xn, A_k_cache, A_v_cache, A_wq, A_wo) + _B_ref(xn, B_w_gate, B_w_up, B_w_down)
```

```asm
; @launch grid=(256,1,1) block=(256,1,1) lds=57344
.amdgcn_target "amdgcn-amd-amdhsa--gfx950"
.text
.globl parallel_sum__gqa_block_cached__glu_gated_bilinear__decode_kernel
.p2align 8
.type parallel_sum__gqa_block_cached__glu_gated_bilinear__decode_kernel,@function
parallel_sum__gqa_block_cached__glu_gated_bilinear__decode_kernel:
    s_cmpk_ge_u32 s2, 256
    s_cbranch_scc1 L_end
    s_load_dwordx2 s[24:25], s[0:1], 24
    s_load_dwordx2 s[8:9], s[0:1], 0
    v_lshrrev_b32 v13, 6, v0
    s_bfe_u32 s50, s2, 0x20003
    v_readfirstlane_b32 s3, v13
    s_lshl1_add_u32 s101, s50, s2
    s_and_b32 s101, s101, 7
    s_lshl2_add_u32 s101, s101, s50
    s_xor_b32 s95, s101, 2
    s_lshr_b32 s4, s2, 5
    s_and_b32 s58, s4, 3
    s_lshl2_add_u32 s58, s58, s3
    s_lshr_b32 s59, s4, 2
    s_lshl1_add_u32 s58, s58, s59
    s_lshl_b32 s58, s58, 5
    v_bfe_u32 v20, v0, 4, 2
    v_lshl_add_u32 v22, v20, 3, s58
    v_and_b32 v23, 15, v0
    s_lshl_b32 s59, s95, 8
    v_lshl_add_u32 v24, v23, 4, s59
    v_lshl_add_u32 v5, v22, 13, v24
    s_mov_b32 s26, 8388608
    s_mov_b32 s27, 0x20000
    s_getpc_b64 s[6:7]
L_p0:
    v_lshlrev_b32 v15, 5, v0
    global_load_ubyte v15, v15, s[6:7]
    s_lshr_b32 s58, s2, 3
    v_lshl_add_u32 v12, s58, 2, v13
    v_lshlrev_b32 v12, 7, v12
    s_waitcnt lgkmcnt(0)
    global_load_ubyte v12, v12, s[8:9]
    buffer_load_dwordx4 v[128:131], v5, s[24:27], 0 offen offset:0 nt
    s_movk_i32 s40, 8192
    buffer_load_dwordx4 v[132:135], v5, s[24:27], s40 offen offset:0 nt
    s_movk_i32 s40, 16384
    buffer_load_dwordx4 v[136:139], v5, s[24:27], s40 offen offset:0 nt
    s_movk_i32 s40, 24576
    buffer_load_dwordx4 v[140:143], v5, s[24:27], s40 offen offset:0 nt
    s_mov_b32 s40, 32768
    buffer_load_dwordx4 v[144:147], v5, s[24:27], s40 offen offset:0 nt
    s_mov_b32 s40, 40960
    buffer_load_dwordx4 v[148:151], v5, s[24:27], s40 offen offset:0 nt
    s_cmp_lt_u32 s2, 128
    s_cselect_b32 s58, 48, 56
    s_load_dwordx2 s[12:13], s[0:1], s58
    s_load_dwordx2 s[32:33], s[0:1], 88
    s_load_dwordx2 s[16:17], s[0:1], 8
    s_load_dwordx2 s[20:21], s[0:1], 16
    s_load_dwordx2 s[28:29], s[0:1], 32
    s_load_dwordx2 s[36:37], s[0:1], 72
    v_and_b32 v1, 63, v0
    s_and_b32 s5, s2, 31
    v_and_b32 v26, 7, v1
    v_and_b32 v21, 8, v1
    v_lshlrev_b32 v27, 11, v26
    v_lshl_add_u32 v27, v22, 1, v27
    v_lshlrev_b32 v28, 3, v21
    v_xor_b32 v70, v27, v28
    s_cmp_lt_u32 s101, 28
    s_cselect_b32 s14, 7340032, 0
    s_mov_b32 s15, 0x20000
    s_movk_i32 s58, 7168
    s_lshl_b32 s59, s101, 8
    v_lshl_add_u32 v24, v23, 4, s59
    v_mad_u32_u24 v68, v22, s58, v24
    v_xor_b32 v22, 32, v22
    v_mad_u32_u24 v69, v22, s58, v24
    s_mov_b32 s34, 16777216
    s_mov_b32 s35, 0x20000
    s_mov_b32 s10, 16384
    s_mov_b32 s11, 0x20000
    s_waitcnt lgkmcnt(0)
    buffer_load_dword v14, off, s[32:35], 0 sc1
    buffer_load_dwordx4 v[104:107], v70, s[8:11], 0 offen
    v_lshlrev_b32 v2, 4, v1
    s_lshl_b32 s58, s5, 15
    s_lshl_b32 s59, s3, 10
    s_add_u32 s58, s58, s59
    s_add_u32 s97, s58, 2097152
    s_lshl_b32 s58, s4, 12
    s_add_u32 s42, s58, s97
    buffer_load_dword v15, v2, s[32:35], s42 offen sc1
    s_waitcnt vmcnt(8)
    s_mov_b32 s40, 49152
    buffer_load_dwordx4 v[152:155], v5, s[24:27], s40 offen offset:0 nt
    s_waitcnt vmcnt(8)
    s_mov_b32 s40, 57344
    buffer_load_dwordx4 v[156:159], v5, s[24:27], s40 offen offset:0 nt
    v_xor_b32 v71, 512, v70
    buffer_load_dwordx4 v[108:111], v71, s[8:11], 0 offen
    s_waitcnt vmcnt(9)
    buffer_load_dwordx4 v[160:163], v68, s[12:15], 0 offen offset:0 nt
    s_waitcnt vmcnt(9)
    s_movk_i32 s40, 4096
    buffer_load_dwordx4 v[164:167], v68, s[12:15], s40 offen offset:3072 nt
    v_xor_b32 v71, 1024, v70
    buffer_load_dwordx4 v[112:115], v71, s[8:11], 0 offen
    s_waitcnt vmcnt(10)
    s_movk_i32 s40, 12288
    buffer_load_dwordx4 v[168:171], v68, s[12:15], s40 offen offset:2048 nt
    s_waitcnt vmcnt(10)
    s_movk_i32 s40, 20480
    buffer_load_dwordx4 v[172:175], v68, s[12:15], s40 offen offset:1024 nt
    s_waitcnt vmcnt(10)
    v_readfirstlane_b32 s49, v14
    v_and_b32 v6, 3, v1
    s_add_u32 s6, s49, 1
    s_and_b32 s46, s6, 0xff
    s_lshr_b32 s47, s6, 8
    s_or_b32 s47, s47, 1
    s_add_u32 s47, s47, s6
    s_and_b32 s47, s47, 0xff
    s_lshl_b32 s49, s47, 16
    s_or_b32 s49, s49, s46
    v_lshlrev_b32 v6, 3, v6
    v_bfe_u32 v6, s49, v6, 8
    s_getreg_b32 s58, hwreg(HW_REG_XCC_ID, 0, 4)
    s_lshl_b32 s58, s58, 8
    s_or_b32 s96, s49, s58
    s_or_b32 s96, s96, 0xa0000000
    s_lshr_b32 s58, s2, 3
    s_lshl_b32 s58, s58, 24
    s_or_b32 s58, s58, s96
    v_mov_b32 v14, s58
    s_and_b32 s58, s2, 7
    s_lshl_b32 s58, s58, 7
    s_add_u32 s41, s58, 4096
    s_lshr_b32 s58, s2, 3
    s_lshl2_add_u32 s43, s58, s41
    s_lshl_b32 s58, s3, 28
    v_mov_b32 v7, s58
    s_mov_b64 exec, 1
    buffer_store_dword v14, v7, s[32:35], s43 offen
    s_mov_b64 exec, -1
    v_xor_b32 v71, 1536, v70
    buffer_load_dwordx4 v[116:119], v71, s[8:11], 0 offen
    s_waitcnt vmcnt(9)
    s_movk_i32 s40, 28672
    buffer_load_dwordx4 v[176:179], v68, s[12:15], s40 offen offset:0 nt
    s_waitcnt vmcnt(9)
    s_mov_b32 s40, 32768
    buffer_load_dwordx4 v[180:183], v68, s[12:15], s40 offen offset:3072 nt
    s_mov_b32 s18, 33554432
    s_mov_b32 s19, 0x20000
    s_mov_b32 s22, 33554432
    s_mov_b32 s23, 0x20000
    s_mov_b32 s30, 8388608
    s_mov_b32 s31, 0x20000
    s_mov_b32 s38, 16384
    s_mov_b32 s39, 0x20000
    s_and_b32 s99, s2, 7
    s_lshl2_add_u32 s99, s99, s50
    s_lshl3_add_u32 s58, s99, s4
    s_lshl_b32 s58, s58, 17
    s_lshl_b32 s59, s3, 12
    s_add_u32 s58, s58, s59
    v_and_b32 v28, 3, v1
    v_lshlrev_b32 v28, 10, v28
    v_and_b32 v29, 4, v1
    v_lshl_add_u32 v28, v29, 6, v28
    v_lshl_add_u32 v28, v21, 3, v28
    v_lshl_add_u32 v28, v20, 4, v28
    v_add_u32 v3, s58, v28
    v_add_u32 v4, s58, v2
    s_mov_b32 s44, 0x05040100
    s_mov_b32 s45, 0x07060302
    s_mov_b32 s51, 0xffff0000
    s_mov_b32 s48, 262144
    v_mov_b32 v11, 0xffffff00
    s_add_u32 s56, s2, 2
    s_and_b32 s56, s56, 7
    s_mul_i32 s98, s50, 7
    s_add_u32 s98, s98, s4
    s_lshl3_add_u32 s50, s50, s4
    v_lshrrev_b32 v28, 3, v1
    v_lshlrev_b32 v29, 7, v26
    v_lshl_add_u32 v8, v28, 4, v29
    v_lshlrev_b32 v29, 4, v26
    v_lshl_add_u32 v127, v28, 12, v29
    v_lshrrev_b32 v29, 2, v1
    v_and_b32 v29, 4, v29
    v_xor_b32 v29, v29, v1
    s_mul_i32 s58, s3, 4352
    v_lshl_add_u32 v9, v29, 4, s58
    v_and_b32 v29, 2, v1
    v_lshlrev_b32 v29, 1, v29
    v_xor_b32 v29, v29, v28
    v_lshl_add_u32 v29, v26, 3, v29
    s_mul_i32 s58, s3, 1088
    v_lshl_add_u32 v10, v29, 4, s58
    v_lshlrev_b32 v126, 2, v1
    s_lshl_b32 s58, s3, 3
    v_lshlrev_b32 v13, 5, v26
    v_add_u32 v12, s58, v13
    s_mul_i32 s58, s99, 3
    s_mul_i32 s59, s4, 1
    s_add_u32 s58, s58, s59
    s_lshr_b32 s59, s99, 2
    s_mul_i32 s59, s59, 0
    s_add_u32 s58, s58, s59
    s_lshl_b32 s94, s58, 14
    v_mov_b32 v16, 0
    v_mov_b32 v17, 0
    v_mov_b32 v18, 0
    v_mov_b32 v19, 0
    v_mov_b32 v20, 0
    v_mov_b32 v21, 0
    v_mov_b32 v22, 0
    v_mov_b32 v23, 0
    v_mov_b32 v24, 0
    v_mov_b32 v25, 0
    v_mov_b32 v26, 0
    v_mov_b32 v27, 0
    v_mov_b32 v28, 0
    v_mov_b32 v29, 0
    v_mov_b32 v30, 0
    v_mov_b32 v31, 0
    s_load_dwordx2 s[24:25], s[0:1], 64
    s_mov_b32 s26, 7340032
    s_waitcnt vmcnt(8)
    s_mov_b32 s40, 40960
    buffer_load_dwordx4 v[184:187], v68, s[12:15], s40 offen offset:2048 nt
    s_waitcnt vmcnt(8)
    s_mov_b32 s40, 49152
    buffer_load_dwordx4 v[188:191], v68, s[12:15], s40 offen offset:1024 nt
    s_waitcnt vmcnt(7)
    buffer_load_dwordx4 v[192:195], v69, s[12:15], 0 offen offset:0 nt
    s_waitcnt vmcnt(7)
    s_movk_i32 s40, 4096
    buffer_load_dwordx4 v[196:199], v69, s[12:15], s40 offen offset:3072 nt
    s_waitcnt vmcnt(6)
    v_and_b32 v73, s51, v104
    v_lshlrev_b32 v72, 16, v104
    v_and_b32 v75, s51, v105
    v_lshlrev_b32 v74, 16, v105
    v_and_b32 v77, s51, v106
    v_lshlrev_b32 v76, 16, v106
    v_and_b32 v79, s51, v107
    v_lshlrev_b32 v78, 16, v107
    v_and_b32 v81, s51, v108
    v_lshlrev_b32 v80, 16, v108
    v_and_b32 v83, s51, v109
    v_lshlrev_b32 v82, 16, v109
    v_and_b32 v85, s51, v110
    v_lshlrev_b32 v84, 16, v110
    v_and_b32 v87, s51, v111
    v_lshlrev_b32 v86, 16, v111
    v_and_b32 v89, s51, v112
    v_lshlrev_b32 v88, 16, v112
    v_and_b32 v91, s51, v113
    v_lshlrev_b32 v90, 16, v113
    v_and_b32 v93, s51, v114
    v_lshlrev_b32 v92, 16, v114
    v_and_b32 v95, s51, v115
    v_lshlrev_b32 v94, 16, v115
    v_and_b32 v97, s51, v116
    v_lshlrev_b32 v96, 16, v116
    v_and_b32 v99, s51, v117
    v_lshlrev_b32 v98, 16, v117
    v_and_b32 v101, s51, v118
    v_lshlrev_b32 v100, 16, v118
    v_and_b32 v103, s51, v119
    v_lshlrev_b32 v102, 16, v119
    v_pk_add_f32 v[120:121], v[72:73], v[74:75]
    v_pk_add_f32 v[122:123], v[76:77], v[78:79]
    v_pk_add_f32 v[120:121], v[120:121], v[80:81]
    v_pk_add_f32 v[122:123], v[122:123], v[82:83]
    v_pk_add_f32 v[120:121], v[120:121], v[84:85]
    v_pk_add_f32 v[122:123], v[122:123], v[86:87]
    v_pk_add_f32 v[120:121], v[120:121], v[88:89]
    v_pk_add_f32 v[122:123], v[122:123], v[90:91]
    v_pk_add_f32 v[120:121], v[120:121], v[92:93]
    v_pk_add_f32 v[122:123], v[122:123], v[94:95]
    v_pk_add_f32 v[120:121], v[120:121], v[96:97]
    v_pk_add_f32 v[122:123], v[122:123], v[98:99]
    v_pk_add_f32 v[120:121], v[120:121], v[100:101]
    v_pk_add_f32 v[122:123], v[122:123], v[102:103]
    v_pk_add_f32 v[120:121], v[120:121], v[122:123]
    v_add_f32 v120, v120, v121
    s_nop 1
    v_add_f32_dpp v120, v120, v120 row_ror:8 row_mask:0xf bank_mask:0xf
    v_mov_b32 v121, v120
    s_nop 1
    v_permlane16_swap_b32 v120, v121
    v_add_f32 v120, v120, v121
    v_mov_b32 v121, v120
    s_nop 1
    v_permlane32_swap_b32 v120, v121
    v_add_f32 v120, v120, v121
    s_waitcnt vmcnt(5)
    s_movk_i32 s40, 12288
    buffer_load_dwordx4 v[200:203], v69, s[12:15], s40 offen offset:2048 nt
    v_mul_f32 v124, 0xbb800000, v120
    v_pk_add_f32 v[104:105], v[72:73], v[124:125] op_sel_hi:[1,0]
    v_pk_add_f32 v[106:107], v[74:75], v[124:125] op_sel_hi:[1,0]
    v_pk_mul_f32 v[120:121], v[104:105], v[104:105]
    v_pk_add_f32 v[108:109], v[76:77], v[124:125] op_sel_hi:[1,0]
    v_pk_mul_f32 v[122:123], v[106:107], v[106:107]
    v_pk_add_f32 v[110:111], v[78:79], v[124:125] op_sel_hi:[1,0]
    v_pk_fma_f32 v[120:121], v[108:109], v[108:109], v[120:121]
    v_pk_add_f32 v[104:105], v[80:81], v[124:125] op_sel_hi:[1,0]
    v_pk_fma_f32 v[122:123], v[110:111], v[110:111], v[122:123]
    v_pk_add_f32 v[106:107], v[82:83], v[124:125] op_sel_hi:[1,0]
    v_pk_fma_f32 v[120:121], v[104:105], v[104:105], v[120:121]
    v_pk_add_f32 v[108:109], v[84:85], v[124:125] op_sel_hi:[1,0]
    v_pk_fma_f32 v[122:123], v[106:107], v[106:107], v[122:123]
    v_pk_add_f32 v[110:111], v[86:87], v[124:125] op_sel_hi:[1,0]
    v_pk_fma_f32 v[120:121], v[108:109], v[108:109], v[120:121]
    v_pk_add_f32 v[104:105], v[88:89], v[124:125] op_sel_hi:[1,0]
    v_pk_fma_f32 v[122:123], v[110:111], v[110:111], v[122:123]
    v_pk_add_f32 v[106:107], v[90:91], v[124:125] op_sel_hi:[1,0]
    v_pk_fma_f32 v[120:121], v[104:105], v[104:105], v[120:121]
    v_pk_add_f32 v[108:109], v[92:93], v[124:125] op_sel_hi:[1,0]
    v_pk_fma_f32 v[122:123], v[106:107], v[106:107], v[122:123]
    v_pk_add_f32 v[110:111], v[94:95], v[124:125] op_sel_hi:[1,0]
    v_pk_fma_f32 v[120:121], v[108:109], v[108:109], v[120:121]
    v_pk_add_f32 v[104:105], v[96:97], v[124:125] op_sel_hi:[1,0]
    v_pk_fma_f32 v[122:123], v[110:111], v[110:111], v[122:123]
    v_pk_add_f32 v[106:107], v[98:99], v[124:125] op_sel_hi:[1,0]
    v_pk_fma_f32 v[120:121], v[104:105], v[104:105], v[120:121]
    v_pk_add_f32 v[108:109], v[100:101], v[124:125] op_sel_hi:[1,0]
    v_pk_fma_f32 v[122:123], v[106:107], v[106:107], v[122:123]
    v_pk_add_f32 v[110:111], v[102:103], v[124:125] op_sel_hi:[1,0]
    v_pk_fma_f32 v[120:121], v[108:109], v[108:109], v[120:121]
    v_pk_fma_f32 v[122:123], v[110:111], v[110:111], v[122:123]
    v_pk_add_f32 v[120:121], v[120:121], v[122:123]
    v_add_f32 v120, v120, v121
    s_nop 1
    v_add_f32_dpp v120, v120, v120 row_ror:8 row_mask:0xf bank_mask:0xf
    v_mov_b32 v121, v120
    s_nop 1
    v_permlane16_swap_b32 v120, v121
    v_add_f32 v120, v120, v121
    v_mov_b32 v121, v120
    s_nop 1
    v_permlane32_swap_b32 v120, v121
    v_add_f32 v120, v120, v121
    v_mov_b32 v125, v120
    ds_write_b64 v12, v[124:125] offset:53248
    s_waitcnt vmcnt(5)
    s_movk_i32 s40, 20480
    buffer_load_dwordx4 v[204:207], v69, s[12:15], s40 offen offset:1024 nt
    s_movk_i32 s40, 28672
    buffer_load_dwordx4 v[208:211], v69, s[12:15], s40 offen offset:0 nt
    s_mov_b32 s40, 32768
    buffer_load_dwordx4 v[212:215], v69, s[12:15], s40 offen offset:3072 nt
    s_waitcnt lgkmcnt(0)
    s_barrier
    ds_read_b128 v[104:107], v13 offset:53248
    ds_read_b128 v[108:111], v13 offset:53264
    s_waitcnt lgkmcnt(0)
    v_pk_add_f32 v[112:113], v[104:105], v[106:107]
    v_pk_add_f32 v[114:115], v[108:109], v[110:111]
    v_pk_add_f32 v[112:113], v[112:113], v[114:115]
    v_mul_f32 v112, 0x3e800000, v112
    v_sub_f32 v104, v104, v112
    v_sub_f32 v106, v106, v112
    v_sub_f32 v108, v108, v112
    v_sub_f32 v110, v110, v112
    v_mul_f32 v114, v104, v104
    v_fmac_f32 v114, v106, v106
    v_fmac_f32 v114, v108, v108
    v_fmac_f32 v114, v110, v110
    v_fmac_f32 v113, 0x43800000, v114
    v_mul_f32 v113, 0x3a800000, v113
    v_cvt_pk_bf16_f32 v112, v112, v113
    v_and_b32 v105, s51, v112
    v_lshlrev_b32 v120, 16, v112
    v_add_f32 v105, 0x3727c5ac, v105
    v_cvt_pk_bf16_f32 v105, v105, v105
    v_lshlrev_b32 v105, 16, v105
    v_sqrt_f32 v105, v105
    s_nop 0
    v_cvt_pk_bf16_f32 v105, v105, v105
    v_lshlrev_b32 v105, 16, v105
    v_rcp_f32 v121, v105
    s_nop 0
    v_pk_add_f32 v[72:73], v[72:73], v[120:121] op_sel_hi:[1,0]
    v_pk_add_f32 v[74:75], v[74:75], v[120:121] op_sel_hi:[1,0]
    v_pk_add_f32 v[76:77], v[76:77], v[120:121] op_sel_hi:[1,0]
    v_pk_add_f32 v[78:79], v[78:79], v[120:121] op_sel_hi:[1,0]
    v_cvt_pk_bf16_f32 v72, v72, v73
    v_cvt_pk_bf16_f32 v74, v74, v75
    v_cvt_pk_bf16_f32 v76, v76, v77
    v_cvt_pk_bf16_f32 v78, v78, v79
    v_and_b32 v73, s51, v72
    v_lshlrev_b32 v72, 16, v72
    v_and_b32 v75, s51, v74
    v_lshlrev_b32 v74, 16, v74
    v_and_b32 v77, s51, v76
    v_lshlrev_b32 v76, 16, v76
    v_and_b32 v79, s51, v78
    v_lshlrev_b32 v78, 16, v78
    v_pk_mul_f32 v[72:73], v[72:73], v[120:121] op_sel:[0,1] op_sel_hi:[1,1]
    v_pk_mul_f32 v[74:75], v[74:75], v[120:121] op_sel:[0,1] op_sel_hi:[1,1]
    v_pk_mul_f32 v[76:77], v[76:77], v[120:121] op_sel:[0,1] op_sel_hi:[1,1]
    v_pk_mul_f32 v[78:79], v[78:79], v[120:121] op_sel:[0,1] op_sel_hi:[1,1]
    v_cvt_pk_bf16_f32 v48, v72, v73
    v_cvt_pk_bf16_f32 v49, v74, v75
    v_cvt_pk_bf16_f32 v50, v76, v77
    v_cvt_pk_bf16_f32 v51, v78, v79
    s_mov_b32 s1, s6
    v_and_b32 v7, 0x7c, v126
    buffer_load_dword v14, v7, s[32:35], s41 offen sc1
    v_mov_b32_dpp v16, v48 quad_perm:[0,1,2,3] row_mask:0xf bank_mask:0x3
    v_mov_b32_dpp v17, v49 quad_perm:[0,1,2,3] row_mask:0xf bank_mask:0x3
    v_mov_b32_dpp v18, v50 quad_perm:[0,1,2,3] row_mask:0xf bank_mask:0x3
    v_mov_b32_dpp v19, v51 quad_perm:[0,1,2,3] row_mask:0xf bank_mask:0x3
    v_mov_b32_dpp v20, v48 row_ror:8 row_mask:0xf bank_mask:0xc
    v_mov_b32_dpp v21, v49 row_ror:8 row_mask:0xf bank_mask:0xc
    v_mov_b32_dpp v22, v50 row_ror:8 row_mask:0xf bank_mask:0xc
    v_mov_b32_dpp v23, v51 row_ror:8 row_mask:0xf bank_mask:0xc
    s_waitcnt vmcnt(6)
    s_mov_b32 s40, 40960
    buffer_load_dwordx4 v[216:219], v69, s[12:15], s40 offen offset:2048 nt
    v_perm_b32 v72, v132, v128, s44
    v_perm_b32 v73, v140, v136, s44
    v_perm_b32 v74, v148, v144, s44
    v_perm_b32 v75, v156, v152, s44
    v_perm_b32 v76, v132, v128, s45
    v_perm_b32 v77, v140, v136, s45
    v_perm_b32 v78, v148, v144, s45
    v_perm_b32 v79, v156, v152, s45
    v_mfma_f32_16x16x32_bf16 v[32:35], v[72:75], v[16:19], 0
    v_perm_b32 v80, v133, v129, s44
    v_perm_b32 v81, v141, v137, s44
    v_perm_b32 v82, v149, v145, s44
    v_perm_b32 v83, v157, v153, s44
    v_mfma_f32_16x16x32_bf16 v[36:39], v[76:79], v[16:19], 0
    v_perm_b32 v84, v133, v129, s45
    v_perm_b32 v85, v141, v137, s45
    v_perm_b32 v86, v149, v145, s45
    v_perm_b32 v87, v157, v153, s45
    v_mfma_f32_16x16x32_bf16 v[40:43], v[80:83], v[16:19], 0
    v_perm_b32 v88, v134, v130, s44
    v_perm_b32 v89, v142, v138, s44
    v_perm_b32 v90, v150, v146, s44
    v_perm_b32 v91, v158, v154, s44
    v_mfma_f32_16x16x32_bf16 v[44:47], v[84:87], v[16:19], 0
    v_perm_b32 v92, v134, v130, s45
    v_perm_b32 v93, v142, v138, s45
    v_perm_b32 v94, v150, v146, s45
    v_perm_b32 v95, v158, v154, s45
    v_mfma_f32_16x16x32_bf16 v[32:35], v[88:91], v[20:23], v[32:35]
    v_perm_b32 v96, v135, v131, s44
    v_perm_b32 v97, v143, v139, s44
    v_perm_b32 v98, v151, v147, s44
    v_perm_b32 v99, v159, v155, s44
    v_mfma_f32_16x16x32_bf16 v[36:39], v[92:95], v[20:23], v[36:39]
    v_perm_b32 v100, v135, v131, s45
    v_perm_b32 v101, v143, v139, s45
    v_perm_b32 v102, v151, v147, s45
    v_perm_b32 v103, v159, v155, s45
    v_mfma_f32_16x16x32_bf16 v[40:43], v[96:99], v[20:23], v[40:43]
    s_nop 0
    v_mfma_f32_16x16x32_bf16 v[44:47], v[100:103], v[20:23], v[44:47]
    s_waitcnt vmcnt(6)
    s_mov_b32 s40, 49152
    buffer_load_dwordx4 v[220:223], v69, s[12:15], s40 offen offset:1024 nt
    ds_write_b128 v9, v[32:35] offset:34816
    ds_write_b128 v9, v[36:39] offset:35904
    s_nop 0
    ds_write_b128 v9, v[40:43] offset:36992
    s_nop 0
    ds_write_b128 v9, v[44:47] offset:38080
    v_perm_b32 v72, v164, v160, s44
    v_perm_b32 v73, v172, v168, s44
    v_perm_b32 v74, v180, v176, s44
    v_perm_b32 v75, v188, v184, s44
    v_perm_b32 v76, v164, v160, s45
    v_perm_b32 v77, v172, v168, s45
    v_perm_b32 v78, v180, v176, s45
    v_perm_b32 v79, v188, v184, s45
    v_mfma_f32_16x16x32_bf16 v[32:35], v[72:75], v[16:19], 0
    v_perm_b32 v80, v165, v161, s44
    v_perm_b32 v81, v173, v169, s44
    v_perm_b32 v82, v181, v177, s44
    v_perm_b32 v83, v189, v185, s44
    v_mfma_f32_16x16x32_bf16 v[36:39], v[76:79], v[16:19], 0
    v_perm_b32 v84, v165, v161, s45
    v_perm_b32 v85, v173, v169, s45
    v_perm_b32 v86, v181, v177, s45
    v_perm_b32 v87, v189, v185, s45
    v_mfma_f32_16x16x32_bf16 v[40:43], v[80:83], v[16:19], 0
    v_perm_b32 v88, v166, v162, s44
    v_perm_b32 v89, v174, v170, s44
    v_perm_b32 v90, v182, v178, s44
    v_perm_b32 v91, v190, v186, s44
    v_mfma_f32_16x16x32_bf16 v[44:47], v[84:87], v[16:19], 0
    v_perm_b32 v92, v166, v162, s45
    v_perm_b32 v93, v174, v170, s45
    v_perm_b32 v94, v182, v178, s45
    v_perm_b32 v95, v190, v186, s45
    v_mfma_f32_16x16x32_bf16 v[32:35], v[88:91], v[20:23], v[32:35]
    v_perm_b32 v96, v167, v163, s44
    v_perm_b32 v97, v175, v171, s44
    v_perm_b32 v98, v183, v179, s44
    v_perm_b32 v99, v191, v187, s44
    v_mfma_f32_16x16x32_bf16 v[36:39], v[92:95], v[20:23], v[36:39]
    v_perm_b32 v100, v167, v163, s45
    v_perm_b32 v101, v175, v171, s45
    v_perm_b32 v102, v183, v179, s45
    v_perm_b32 v103, v191, v187, s45
    v_mfma_f32_16x16x32_bf16 v[40:43], v[96:99], v[20:23], v[40:43]
    s_nop 0
    v_mfma_f32_16x16x32_bf16 v[44:47], v[100:103], v[20:23], v[44:47]
    v_mov_b32_dpp v16, v48 row_ror:8 row_mask:0xf bank_mask:0x3
    v_mov_b32_dpp v17, v49 row_ror:8 row_mask:0xf bank_mask:0x3
    v_mov_b32_dpp v18, v50 row_ror:8 row_mask:0xf bank_mask:0x3
    v_mov_b32_dpp v19, v51 row_ror:8 row_mask:0xf bank_mask:0x3
    v_mov_b32_dpp v20, v48 quad_perm:[0,1,2,3] row_mask:0xf bank_mask:0xc
    v_mov_b32_dpp v21, v49 quad_perm:[0,1,2,3] row_mask:0xf bank_mask:0xc
    v_mov_b32_dpp v22, v50 quad_perm:[0,1,2,3] row_mask:0xf bank_mask:0xc
    v_mov_b32_dpp v23, v51 quad_perm:[0,1,2,3] row_mask:0xf bank_mask:0xc
    s_add_u32 s40, s94, 0
    s_and_b32 s40, s40, 0x1c000
    buffer_load_dwordx4 a[0:3], v3, s[16:19], s40 offen offset:0 nt
    s_waitcnt vmcnt(7)
    s_add_u32 s40, s94, 16384
    s_and_b32 s40, s40, 0x1c000
    buffer_load_dwordx4 a[16:19], v3, s[16:19], s40 offen offset:0 nt
    s_waitcnt vmcnt(7)
    s_add_u32 s40, s94, 0
    s_and_b32 s40, s40, 0x1c000
    buffer_load_dwordx4 a[4:7], v3, s[16:19], s40 offen offset:128 nt
    s_waitcnt vmcnt(7)
    s_add_u32 s40, s94, 16384
    s_and_b32 s40, s40, 0x1c000
    buffer_load_dwordx4 a[20:23], v3, s[16:19], s40 offen offset:128 nt
    s_movk_i32 s49, 40
L_chk_xt:
    s_waitcnt vmcnt(6)
    v_lshlrev_b32 v15, 22, v7
    v_xor_b32 v14, s96, v14
    v_xor_b32 v14, v15, v14
    v_cmp_ne_u32 s[58:59], 0, v14
    v_and_b32 v14, 0xffff00ff, v14
    v_cmp_ne_u32 vcc, 0, v14
    s_cmp_eq_u64 s[58:59], 0
    s_cselect_b32 s57, 1, 0
    s_cbranch_vccnz L_retry_xt
L_ok_xt:
    s_lshl_b32 s58, s4, 7
    s_add_u32 s54, s58, s97
    s_add_u32 s43, s54, 0
    s_waitcnt lgkmcnt(0)
    s_barrier
    ds_read_b128 v[104:107], v10 offset:34816
    ds_read_b128 v[108:111], v10 offset:39168
    ds_read_b128 v[112:115], v10 offset:43520
    ds_read_b128 v[116:119], v10 offset:47872
    s_waitcnt lgkmcnt(2)
    v_pk_add_f32 v[104:105], v[104:105], v[108:109]
    v_pk_add_f32 v[106:107], v[106:107], v[110:111]
    s_waitcnt lgkmcnt(0)
    v_pk_add_f32 v[112:113], v[112:113], v[116:117]
    v_pk_add_f32 v[114:115], v[114:115], v[118:119]
    v_pk_add_f32 v[104:105], v[104:105], v[112:113]
    v_pk_add_f32 v[106:107], v[106:107], v[114:115]
    v_add_u32 v104, 0x80, v104
    v_add_u32 v106, 0x80, v106
    v_and_or_b32 v104, v104, v11, s46
    v_and_or_b32 v106, v106, v11, s47
    s_cmp_eq_u32 s57, 0
    s_cbranch_scc1 L_far_qst
    buffer_store_dwordx4 v[104:107], v127, s[32:35], s43 offen
L_back_qst:
    s_add_u32 s40, s94, 0
    s_and_b32 s40, s40, 0x1c000
    buffer_load_dwordx4 a[8:11], v3, s[16:19], s40 offen offset:512 nt
    s_waitcnt vmcnt(7)
    s_add_u32 s40, s94, 16384
    s_and_b32 s40, s40, 0x1c000
    buffer_load_dwordx4 a[24:27], v3, s[16:19], s40 offen offset:512 nt
    s_waitcnt vmcnt(7)
    s_add_u32 s40, s94, 0
    s_and_b32 s40, s40, 0x1c000
    buffer_load_dwordx4 a[12:15], v3, s[16:19], s40 offen offset:640 nt
    v_perm_b32 v72, v196, v192, s44
    v_perm_b32 v73, v204, v200, s44
    v_perm_b32 v74, v212, v208, s44
    v_perm_b32 v75, v220, v216, s44
    v_perm_b32 v76, v196, v192, s45
    v_perm_b32 v77, v204, v200, s45
    v_perm_b32 v78, v212, v208, s45
    v_perm_b32 v79, v220, v216, s45
    v_mfma_f32_16x16x32_bf16 v[32:35], v[72:75], v[16:19], v[32:35]
    v_perm_b32 v80, v197, v193, s44
    v_perm_b32 v81, v205, v201, s44
    v_perm_b32 v82, v213, v209, s44
    v_perm_b32 v83, v221, v217, s44
    v_mfma_f32_16x16x32_bf16 v[36:39], v[76:79], v[16:19], v[36:39]
    v_perm_b32 v84, v197, v193, s45
    v_perm_b32 v85, v205, v201, s45
    v_perm_b32 v86, v213, v209, s45
    v_perm_b32 v87, v221, v217, s45
    v_mfma_f32_16x16x32_bf16 v[40:43], v[80:83], v[16:19], v[40:43]
    v_perm_b32 v88, v198, v194, s44
    v_perm_b32 v89, v206, v202, s44
    v_perm_b32 v90, v214, v210, s44
    v_perm_b32 v91, v222, v218, s44
    v_mfma_f32_16x16x32_bf16 v[44:47], v[84:87], v[16:19], v[44:47]
    v_perm_b32 v92, v198, v194, s45
    v_perm_b32 v93, v206, v202, s45
    v_perm_b32 v94, v214, v210, s45
    v_perm_b32 v95, v222, v218, s45
    v_mfma_f32_16x16x32_bf16 v[32:35], v[88:91], v[20:23], v[32:35]
    v_perm_b32 v96, v199, v195, s44
    v_perm_b32 v97, v207, v203, s44
    v_perm_b32 v98, v215, v211, s44
    v_perm_b32 v99, v223, v219, s44
    v_mfma_f32_16x16x32_bf16 v[36:39], v[92:95], v[20:23], v[36:39]
    v_perm_b32 v100, v199, v195, s45
    v_perm_b32 v101, v207, v203, s45
    v_perm_b32 v102, v215, v211, s45
    v_perm_b32 v103, v223, v219, s45
    v_mfma_f32_16x16x32_bf16 v[40:43], v[96:99], v[20:23], v[40:43]
    s_nop 0
    v_mfma_f32_16x16x32_bf16 v[44:47], v[100:103], v[20:23], v[44:47]
    s_waitcnt vmcnt(7)
    s_add_u32 s40, s94, 16384
    s_and_b32 s40, s40, 0x1c000
    buffer_load_dwordx4 a[28:31], v3, s[16:19], s40 offen offset:640 nt
    ds_write_b128 v9, v[32:35] offset:17408
    ds_write_b128 v9, v[36:39] offset:18496
    ds_write_b128 v9, v[40:43] offset:19584
    s_nop 0
    ds_write_b128 v9, v[44:47] offset:20672
    s_mov_b32 s43, s54
    s_waitcnt lgkmcnt(0)
    s_barrier
    ds_read_b128 v[104:107], v10 offset:17408
    ds_read_b128 v[108:111], v10 offset:21760
    ds_read_b128 v[112:115], v10 offset:26112
    ds_read_b128 v[116:119], v10 offset:30464
    s_waitcnt lgkmcnt(2)
    v_pk_add_f32 v[104:105], v[104:105], v[108:109]
    v_pk_add_f32 v[106:107], v[106:107], v[110:111]
    s_waitcnt lgkmcnt(0)
    v_pk_add_f32 v[112:113], v[112:113], v[116:117]
    v_pk_add_f32 v[114:115], v[114:115], v[118:119]
    v_pk_add_f32 v[104:105], v[104:105], v[112:113]
    v_pk_add_f32 v[106:107], v[106:107], v[114:115]
    v_add_u32 v104, 0x80, v104
    v_add_u32 v106, 0x80, v106
    s_add_u32 s12, s46, 96
    s_and_b32 s12, s12, 0xff
    s_add_u32 s13, s47, 96
    s_and_b32 s13, s13, 0xff
    v_and_or_b32 v64, v104, v11, s12
    v_mov_b32 v65, v105
    v_and_or_b32 v66, v106, v11, s13
    v_mov_b32 v67, v107
    s_waitcnt vmcnt(7)
    s_add_u32 s40, s94, 32768
    s_and_b32 s40, s40, 0x1c000
    buffer_load_dwordx4 a[32:35], v3, s[16:19], s40 offen offset:0 nt
    s_waitcnt vmcnt(7)
    s_add_u32 s40, s94, 49152
    s_and_b32 s40, s40, 0x1c000
    buffer_load_dwordx4 a[48:51], v3, s[16:19], s40 offen offset:0 nt
    s_waitcnt vmcnt(7)
    s_add_u32 s40, s94, 32768
    s_and_b32 s40, s40, 0x1c000
    buffer_load_dwordx4 a[36:39], v3, s[16:19], s40 offen offset:128 nt
    s_waitcnt vmcnt(6)
    s_add_u32 s40, s94, 49152
    s_and_b32 s40, s40, 0x1c000
    buffer_load_dwordx4 a[52:55], v3, s[16:19], s40 offen offset:128 nt
    s_waitcnt vmcnt(6)
    s_add_u32 s40, s94, 32768
    s_and_b32 s40, s40, 0x1c000
    buffer_load_dwordx4 a[40:43], v3, s[16:19], s40 offen offset:512 nt
    s_add_u32 s41, s42, 0
    buffer_load_dwordx4 v[108:111], v2, s[32:35], s41 offen offset:0 sc1
    s_lshr_b32 s58, s95, 3
    s_lshl2_add_u32 s58, s4, s58
    s_lshl2_add_u32 s58, s58, s3
    s_and_b32 s59, s95, 7
    s_lshl3_add_u32 s58, s58, s59
    s_lshl_b32 s58, s58, 7
    s_add_u32 s43, s58, 1048576
    s_waitcnt vmcnt(7)
    s_add_u32 s40, s94, 49152
    s_and_b32 s40, s40, 0x1c000
    buffer_load_dwordx4 a[56:59], v3, s[16:19], s40 offen offset:512 nt
    s_waitcnt vmcnt(7)
    s_add_u32 s40, s94, 32768
    s_and_b32 s40, s40, 0x1c000
    buffer_load_dwordx4 a[44:47], v3, s[16:19], s40 offen offset:640 nt
    s_waitcnt vmcnt(7)
    s_add_u32 s40, s94, 49152
    s_and_b32 s40, s40, 0x1c000
    buffer_load_dwordx4 a[60:63], v3, s[16:19], s40 offen offset:640 nt
    s_waitcnt vmcnt(7)
    s_add_u32 s40, s94, 65536
    s_and_b32 s40, s40, 0x1c000
    buffer_load_dwordx4 a[64:67], v3, s[16:19], s40 offen offset:0 nt
    s_waitcnt vmcnt(7)
    s_add_u32 s40, s94, 81920
    s_and_b32 s40, s40, 0x1c000
    buffer_load_dwordx4 a[80:83], v3, s[16:19], s40 offen offset:0 nt
    s_waitcnt vmcnt(7)
    s_add_u32 s40, s94, 65536
    s_and_b32 s40, s40, 0x1c000
    buffer_load_dwordx4 a[68:71], v3, s[16:19], s40 offen offset:128 nt
    s_waitcnt vmcnt(7)
    s_add_u32 s40, s94, 81920
    s_and_b32 s40, s40, 0x1c000
    buffer_load_dwordx4 a[84:87], v3, s[16:19], s40 offen offset:128 nt
L_chk_q1:
    s_waitcnt vmcnt(7)
    v_xor_b32 v108, s46, v108
    v_xor_b32 v110, s47, v110
    v_or_b32 v15, v108, v110
    v_and_b32 v15, 0xff, v15
    v_cmp_ne_u32 vcc, 0, v15
    s_nop 0
    s_cbranch_vccnz L_retry_q1
L_ok_q1:
    v_add_f32_dpp v104, v109, v109 row_ror:8 row_mask:0xf bank_mask:0xc
    v_add_f32_dpp v105, v111, v111 row_ror:8 row_mask:0xf bank_mask:0xc
    s_nop 0
    v_add_f32_dpp v104, v108, v108 row_ror:8 row_mask:0xf bank_mask:0x3
    v_add_f32_dpp v105, v110, v110 row_ror:8 row_mask:0xf bank_mask:0x3
    s_nop 1
    v_permlane16_swap_b32 v104, v105
    v_add_f32 v104, v104, v105
    v_mov_b32 v105, v104
    s_nop 1
    v_permlane32_swap_b32 v104, v105
    v_add_f32 v104, v104, v105
    s_and_b32 s58, s2, 7
    s_cmp_eq_u32 s58, s4
    s_cselect_b32 s49, s57, 0
    v_cvt_pk_bf16_f32 v104, v104, v104
    v_and_or_b32 v104, v104, s51, v6
    s_nop 1
    v_mov_b32_dpp v105, v104 quad_perm:[1,1,1,1] row_mask:0xf bank_mask:0xf
    v_mov_b32_dpp v106, v104 quad_perm:[2,2,2,2] row_mask:0xf bank_mask:0xf
    v_mov_b32_dpp v107, v104 quad_perm:[3,3,3,3] row_mask:0xf bank_mask:0xf
    s_mov_b64 exec, 0x11111111
    s_cmp_eq_u32 s49, 0
    s_cbranch_scc1 L_far_q2st
    buffer_store_dwordx4 v[104:107], v126, s[32:35], s43 offen
L_back_q2st:
    s_mov_b64 exec, -1
    s_lshl2_add_u32 s58, s5, s3
    s_lshl_b32 s58, s58, 7
    s_add_u32 s41, s58, 16384
    s_lshl4_add_u32 s43, s4, s41
    s_or_b32 s52, s46, 0x5ac3e100
    s_or_b32 s53, s47, 0x93b7d400
    v_mov_b32 v116, s52
    v_mov_b32 v118, s53
    v_and_b32 v120, 0x70, v2
    s_mov_b64 exec, 1
    s_cmp_eq_u32 s57, 0
    s_cbranch_scc1 L_far_akst
    buffer_store_dwordx4 v[116:119], v2, s[32:35], s43 offen
L_back_akst:
    s_mov_b64 exec, -1
    s_waitcnt vmcnt(8)
    s_add_u32 s40, s94, 65536
    s_and_b32 s40, s40, 0x1c000
    buffer_load_dwordx4 a[72:75], v3, s[16:19], s40 offen offset:512 nt
    s_waitcnt vmcnt(8)
    s_add_u32 s40, s94, 81920
    s_and_b32 s40, s40, 0x1c000
    buffer_load_dwordx4 a[88:91], v3, s[16:19], s40 offen offset:512 nt
    s_waitcnt vmcnt(8)
    s_add_u32 s40, s94, 65536
    s_and_b32 s40, s40, 0x1c000
    buffer_load_dwordx4 a[76:79], v3, s[16:19], s40 offen offset:640 nt
    s_waitcnt vmcnt(8)
    s_add_u32 s40, s94, 81920
    s_and_b32 s40, s40, 0x1c000
    buffer_load_dwordx4 a[92:95], v3, s[16:19], s40 offen offset:640 nt
    s_waitcnt vmcnt(8)
    s_add_u32 s40, s94, 98304
    s_and_b32 s40, s40, 0x1c000
    buffer_load_dwordx4 a[96:99], v3, s[16:19], s40 offen offset:0 nt
    s_waitcnt vmcnt(8)
    s_add_u32 s40, s94, 114688
    s_and_b32 s40, s40, 0x1c000
    buffer_load_dwordx4 a[112:115], v3, s[16:19], s40 offen offset:0 nt
    s_waitcnt vmcnt(8)
    s_add_u32 s40, s94, 98304
    s_and_b32 s40, s40, 0x1c000
    buffer_load_dwordx4 a[100:103], v3, s[16:19], s40 offen offset:128 nt
    buffer_load_dwordx4 v[112:115], v120, s[32:35], s41 offen offset:0 sc1
    s_mov_b32 s96, s41
    s_waitcnt vmcnt(7)
    s_add_u32 s40, s94, 114688
    s_and_b32 s40, s40, 0x1c000
    buffer_load_dwordx4 a[116:119], v3, s[16:19], s40 offen offset:128 nt
    s_waitcnt vmcnt(7)
    s_add_u32 s40, s94, 98304
    s_and_b32 s40, s40, 0x1c000
    buffer_load_dwordx4 a[104:107], v3, s[16:19], s40 offen offset:512 nt
    s_waitcnt vmcnt(7)
    s_add_u32 s40, s94, 114688
    s_and_b32 s40, s40, 0x1c000
    buffer_load_dwordx4 a[120:123], v3, s[16:19], s40 offen offset:512 nt
    s_waitcnt vmcnt(7)
    s_add_u32 s40, s94, 98304
    s_and_b32 s40, s40, 0x1c000
    buffer_load_dwordx4 a[108:111], v3, s[16:19], s40 offen offset:640 nt
    s_lshl2_add_u32 s58, s99, s3
    s_lshl_b32 s58, s58, 10
    s_add_u32 s41, s58, 1048576
    buffer_load_dwordx4 v[108:111], v8, s[32:35], s41 offen offset:0 sc1
    v_and_b32 v124, 7, v1
    v_mul_u32_u24 v72, 272, v124
    v_lshrrev_b32 v73, 4, v1
    v_and_b32 v74, 8, v1
    v_lshl_add_u32 v72, v73, 4, v72
    v_lshl_add_u32 v12, v74, 4, v72
    s_lshl_b32 s58, s3, 1
    v_add_u32 v12, s58, v12
    v_lshl_add_u32 v13, v74, 3, v72
    v_xor_b32 v74, 8, v74
    v_lshl_add_u32 v5, v74, 3, v72
    v_lshrrev_b32 v125, 3, v1
    s_waitcnt vmcnt(8)
    s_add_u32 s40, s94, 114688
    s_and_b32 s40, s40, 0x1c000
    buffer_load_dwordx4 a[124:127], v3, s[16:19], s40 offen offset:640 nt
    s_waitcnt vmcnt(8)
    s_add_u32 s40, s94, 0
    s_and_b32 s40, s40, 0x1c000
    buffer_load_dwordx4 v[192:195], v4, s[20:23], s40 offen offset:0 nt
    s_waitcnt vmcnt(8)
    s_add_u32 s40, s94, 16384
    s_and_b32 s40, s40, 0x1c000
    buffer_load_dwordx4 v[208:211], v4, s[20:23], s40 offen offset:0 nt
L_chk_ak:
    s_waitcnt vmcnt(8)
    v_xor_b32 v112, s52, v112
    v_xor_b32 v114, s53, v114
    v_or_b32 v15, v112, v114
    v_cmp_ne_u32 vcc, 0, v15
    s_nop 0
    s_cbranch_vccnz L_retry_ak
L_ok_ak:
    s_mov_b32 s43, s54
    s_cmp_eq_u32 s57, 0
    s_cbranch_scc1 L_far_tst
    buffer_store_dwordx4 v[64:67], v127, s[32:35], s43 offen
L_back_tst:
    s_waitcnt vmcnt(8)
    s_add_u32 s40, s94, 0
    s_and_b32 s40, s40, 0x1c000
    buffer_load_dwordx4 v[196:199], v4, s[20:23], s40 offen offset:1024 nt
    s_waitcnt vmcnt(8)
    s_add_u32 s40, s94, 16384
    s_and_b32 s40, s40, 0x1c000
    buffer_load_dwordx4 v[212:215], v4, s[20:23], s40 offen offset:1024 nt
    s_waitcnt vmcnt(8)
    s_add_u32 s40, s94, 0
    s_and_b32 s40, s40, 0x1c000
    buffer_load_dwordx4 v[200:203], v4, s[20:23], s40 offen offset:2048 nt
    s_waitcnt vmcnt(8)
    s_add_u32 s40, s94, 16384
    s_and_b32 s40, s40, 0x1c000
    buffer_load_dwordx4 v[216:219], v4, s[20:23], s40 offen offset:2048 nt
L_chk_q:
    s_waitcnt vmcnt(8)
    v_xor_b32 v108, s46, v108
    v_xor_b32 v110, s47, v110
    v_or_b32 v15, v108, v110
    v_and_b32 v15, 0xff, v15
    v_cmp_ne_u32 vcc, 0, v15
    s_nop 0
    s_cbranch_vccnz L_retry_q
L_ok_q:
    ds_write_b16_d16_hi v12, v108 offset:53760
    ds_write_b16_d16_hi v12, v109 offset:53768
    ds_write_b16_d16_hi v12, v110 offset:53824
    ds_write_b16_d16_hi v12, v111 offset:53832
    s_waitcnt vmcnt(7)
    s_add_u32 s40, s94, 0
    s_and_b32 s40, s40, 0x1c000
    buffer_load_dwordx4 v[204:207], v4, s[20:23], s40 offen offset:3072 nt
    s_waitcnt lgkmcnt(0)
    s_barrier
    ds_read_b128 v[72:75], v13 offset:53760
    ds_read_b128 v[76:79], v13 offset:53888
    ds_read_b128 v[80:83], v5 offset:53760
    ds_read_b128 v[84:87], v5 offset:53888
    s_lshl_b32 s58, s3, 3
    v_lshl_add_u32 v12, v124, 5, s58
    v_lshlrev_b32 v13, 5, v125
    s_mov_b32 s58, 0x3db504f3
    s_mov_b32 s59, 0x3db504f3
    s_waitcnt lgkmcnt(0)
    v_mfma_f32_16x16x32_bf16 v[88:91], a[0:3], v[72:75], 0
    v_mfma_f32_16x16x32_bf16 v[92:95], a[8:11], v[72:75], 0
    v_mfma_f32_16x16x32_bf16 v[88:91], a[4:7], v[76:79], v[88:91]
    v_mfma_f32_16x16x32_bf16 v[92:95], a[12:15], v[76:79], v[92:95]
    s_waitcnt vmcnt(7)
    s_add_u32 s40, s94, 16384
    s_and_b32 s40, s40, 0x1c000
    buffer_load_dwordx4 v[220:223], v4, s[20:23], s40 offen offset:3072 nt
    v_mfma_f32_16x16x32_bf16 v[96:99], a[16:19], v[72:75], 0
    v_mfma_f32_16x16x32_bf16 v[100:103], a[24:27], v[72:75], 0
    v_mfma_f32_16x16x32_bf16 v[96:99], a[20:23], v[76:79], v[96:99]
    v_mfma_f32_16x16x32_bf16 v[100:103], a[28:31], v[76:79], v[100:103]
    v_permlane32_swap_b32 v88, v92
    v_permlane32_swap_b32 v89, v93
    v_permlane32_swap_b32 v90, v94
    v_permlane32_swap_b32 v91, v95
    v_add_f32_dpp v48, v92, v88 row_ror:8 row_mask:0xf bank_mask:0x3
    v_add_f32_dpp v49, v93, v89 row_ror:8 row_mask:0xf bank_mask:0x3
    v_add_f32_dpp v50, v94, v90 row_ror:8 row_mask:0xf bank_mask:0x3
    v_add_f32_dpp v51, v95, v91 row_ror:8 row_mask:0xf bank_mask:0x3
    v_mfma_f32_16x16x32_bf16 v[88:91], a[32:35], v[80:83], 0
    v_mfma_f32_16x16x32_bf16 v[92:95], a[40:43], v[80:83], 0
    v_mfma_f32_16x16x32_bf16 v[88:91], a[36:39], v[84:87], v[88:91]
    v_mfma_f32_16x16x32_bf16 v[92:95], a[44:47], v[84:87], v[92:95]
    v_permlane32_swap_b32 v96, v100
    v_permlane32_swap_b32 v97, v101
    v_permlane32_swap_b32 v98, v102
    v_permlane32_swap_b32 v99, v103
    v_add_f32_dpp v52, v100, v96 row_ror:8 row_mask:0xf bank_mask:0x3
    v_add_f32_dpp v53, v101, v97 row_ror:8 row_mask:0xf bank_mask:0x3
    v_add_f32_dpp v54, v102, v98 row_ror:8 row_mask:0xf bank_mask:0x3
    v_add_f32_dpp v55, v103, v99 row_ror:8 row_mask:0xf bank_mask:0x3
    s_waitcnt vmcnt(7)
    s_add_u32 s40, s94, 32768
    s_and_b32 s40, s40, 0x1c000
    buffer_load_dwordx4 v[224:227], v4, s[20:23], s40 offen offset:0 nt
    v_mfma_f32_16x16x32_bf16 v[96:99], a[48:51], v[80:83], 0
    v_mfma_f32_16x16x32_bf16 v[100:103], a[56:59], v[80:83], 0
    v_mfma_f32_16x16x32_bf16 v[96:99], a[52:55], v[84:87], v[96:99]
    v_mfma_f32_16x16x32_bf16 v[100:103], a[60:63], v[84:87], v[100:103]
    v_permlane32_swap_b32 v88, v92
    v_permlane32_swap_b32 v89, v93
    v_permlane32_swap_b32 v90, v94
    v_permlane32_swap_b32 v91, v95
    v_add_f32_dpp v48, v92, v88 row_ror:8 row_mask:0xf bank_mask:0xc
    v_add_f32_dpp v49, v93, v89 row_ror:8 row_mask:0xf bank_mask:0xc
    v_add_f32_dpp v50, v94, v90 row_ror:8 row_mask:0xf bank_mask:0xc
    v_add_f32_dpp v51, v95, v91 row_ror:8 row_mask:0xf bank_mask:0xc
    v_mfma_f32_16x16x32_bf16 v[88:91], a[64:67], v[72:75], 0
    v_mfma_f32_16x16x32_bf16 v[92:95], a[72:75], v[72:75], 0
    v_mfma_f32_16x16x32_bf16 v[88:91], a[68:71], v[76:79], v[88:91]
    v_mfma_f32_16x16x32_bf16 v[92:95], a[76:79], v[76:79], v[92:95]
    v_permlane32_swap_b32 v96, v100
    v_permlane32_swap_b32 v97, v101
    v_permlane32_swap_b32 v98, v102
    v_permlane32_swap_b32 v99, v103
    v_add_f32_dpp v52, v100, v96 row_ror:8 row_mask:0xf bank_mask:0xc
    v_add_f32_dpp v53, v101, v97 row_ror:8 row_mask:0xf bank_mask:0xc
    v_add_f32_dpp v54, v102, v98 row_ror:8 row_mask:0xf bank_mask:0xc
    v_add_f32_dpp v55, v103, v99 row_ror:8 row_mask:0xf bank_mask:0xc
    v_cvt_pk_bf16_f32 v48, v48, v49
    v_cvt_pk_bf16_f32 v50, v50, v51
    v_cvt_pk_bf16_f32 v52, v52, v53
    v_cvt_pk_bf16_f32 v54, v54, v55
    v_and_b32 v49, s51, v48
    v_lshlrev_b32 v48, 16, v48
    v_and_b32 v51, s51, v50
    v_lshlrev_b32 v50, 16, v50
    v_and_b32 v53, s51, v52
    v_lshlrev_b32 v52, 16, v52
    v_and_b32 v55, s51, v54
    v_lshlrev_b32 v54, 16, v54
    v_pk_mul_f32 v[48:49], v[48:49], s[58:59]
    v_pk_mul_f32 v[50:51], v[50:51], s[58:59]
    v_pk_mul_f32 v[52:53], v[52:53], s[58:59]
    v_pk_mul_f32 v[54:55], v[54:55], s[58:59]
    v_cvt_pk_bf16_f32 v48, v48, v49
    v_cvt_pk_bf16_f32 v50, v50, v51
    v_cvt_pk_bf16_f32 v52, v52, v53
    v_cvt_pk_bf16_f32 v54, v54, v55
    v_and_b32 v49, s51, v48
    v_lshlrev_b32 v48, 16, v48
    v_and_b32 v51, s51, v50
    v_lshlrev_b32 v50, 16, v50
    v_and_b32 v53, s51, v52
    v_lshlrev_b32 v52, 16, v52
    v_and_b32 v55, s51, v54
    v_lshlrev_b32 v54, 16, v54
    s_waitcnt vmcnt(6)
    s_add_u32 s40, s94, 49152
    s_and_b32 s40, s40, 0x1c000
    buffer_load_dwordx4 v[240:243], v4, s[20:23], s40 offen offset:0 nt
    v_mfma_f32_16x16x32_bf16 v[96:99], a[80:83], v[72:75], 0
    v_mfma_f32_16x16x32_bf16 v[100:103], a[88:91], v[72:75], 0
    v_mfma_f32_16x16x32_bf16 v[96:99], a[84:87], v[76:79], v[96:99]
    v_mfma_f32_16x16x32_bf16 v[100:103], a[92:95], v[76:79], v[100:103]
    v_permlane32_swap_b32 v88, v92
    v_permlane32_swap_b32 v89, v93
    v_permlane32_swap_b32 v90, v94
    v_permlane32_swap_b32 v91, v95
    v_add_f32_dpp v56, v92, v88 row_ror:8 row_mask:0xf bank_mask:0x3
    v_add_f32_dpp v57, v93, v89 row_ror:8 row_mask:0xf bank_mask:0x3
    v_add_f32_dpp v58, v94, v90 row_ror:8 row_mask:0xf bank_mask:0x3
    v_add_f32_dpp v59, v95, v91 row_ror:8 row_mask:0xf bank_mask:0x3
    v_mfma_f32_16x16x32_bf16 v[88:91], a[96:99], v[80:83], 0
    v_mfma_f32_16x16x32_bf16 v[92:95], a[104:107], v[80:83], 0
    v_mfma_f32_16x16x32_bf16 v[88:91], a[100:103], v[84:87], v[88:91]
    v_mfma_f32_16x16x32_bf16 v[92:95], a[108:111], v[84:87], v[92:95]
    v_permlane32_swap_b32 v96, v100
    v_permlane32_swap_b32 v97, v101
    v_permlane32_swap_b32 v98, v102
    v_permlane32_swap_b32 v99, v103
    v_add_f32_dpp v60, v100, v96 row_ror:8 row_mask:0xf bank_mask:0x3
    v_add_f32_dpp v61, v101, v97 row_ror:8 row_mask:0xf bank_mask:0x3
    v_add_f32_dpp v62, v102, v98 row_ror:8 row_mask:0xf bank_mask:0x3
    v_add_f32_dpp v63, v103, v99 row_ror:8 row_mask:0xf bank_mask:0x3
    s_waitcnt vmcnt(6)
    s_add_u32 s40, s94, 32768
    s_and_b32 s40, s40, 0x1c000
    buffer_load_dwordx4 v[228:231], v4, s[20:23], s40 offen offset:1024 nt
    v_mfma_f32_16x16x32_bf16 v[96:99], a[112:115], v[80:83], 0
    v_mfma_f32_16x16x32_bf16 v[100:103], a[120:123], v[80:83], 0
    v_mfma_f32_16x16x32_bf16 v[96:99], a[116:119], v[84:87], v[96:99]
    v_mfma_f32_16x16x32_bf16 v[100:103], a[124:127], v[84:87], v[100:103]
    v_permlane32_swap_b32 v88, v92
    v_permlane32_swap_b32 v89, v93
    v_permlane32_swap_b32 v90, v94
    v_permlane32_swap_b32 v91, v95
    v_add_f32_dpp v56, v92, v88 row_ror:8 row_mask:0xf bank_mask:0xc
    v_add_f32_dpp v57, v93, v89 row_ror:8 row_mask:0xf bank_mask:0xc
    v_add_f32_dpp v58, v94, v90 row_ror:8 row_mask:0xf bank_mask:0xc
    v_add_f32_dpp v59, v95, v91 row_ror:8 row_mask:0xf bank_mask:0xc
    v_permlane32_swap_b32 v96, v100
    v_permlane32_swap_b32 v97, v101
    v_permlane32_swap_b32 v98, v102
    v_permlane32_swap_b32 v99, v103
    v_add_f32_dpp v60, v100, v96 row_ror:8 row_mask:0xf bank_mask:0xc
    v_add_f32_dpp v61, v101, v97 row_ror:8 row_mask:0xf bank_mask:0xc
    v_add_f32_dpp v62, v102, v98 row_ror:8 row_mask:0xf bank_mask:0xc
    v_add_f32_dpp v63, v103, v99 row_ror:8 row_mask:0xf bank_mask:0xc
    v_cvt_pk_bf16_f32 v56, v56, v57
    v_cvt_pk_bf16_f32 v58, v58, v59
    v_cvt_pk_bf16_f32 v60, v60, v61
    v_cvt_pk_bf16_f32 v62, v62, v63
    v_and_b32 v57, s51, v56
    v_lshlrev_b32 v56, 16, v56
    v_and_b32 v59, s51, v58
    v_lshlrev_b32 v58, 16, v58
    v_and_b32 v61, s51, v60
    v_lshlrev_b32 v60, 16, v60
    v_and_b32 v63, s51, v62
    v_lshlrev_b32 v62, 16, v62
    v_pk_mul_f32 v[56:57], v[56:57], s[58:59]
    v_pk_mul_f32 v[58:59], v[58:59], s[58:59]
    v_pk_mul_f32 v[60:61], v[60:61], s[58:59]
    v_pk_mul_f32 v[62:63], v[62:63], s[58:59]
    v_cvt_pk_bf16_f32 v56, v56, v57
    v_cvt_pk_bf16_f32 v58, v58, v59
    v_cvt_pk_bf16_f32 v60, v60, v61
    v_cvt_pk_bf16_f32 v62, v62, v63
    v_and_b32 v57, s51, v56
    v_lshlrev_b32 v56, 16, v56
    v_and_b32 v59, s51, v58
    v_lshlrev_b32 v58, 16, v58
    v_and_b32 v61, s51, v60
    v_lshlrev_b32 v60, 16, v60
    v_and_b32 v63, s51, v62
    v_lshlrev_b32 v62, 16, v62
    s_waitcnt vmcnt(6)
    s_add_u32 s40, s94, 49152
    s_and_b32 s40, s40, 0x1c000
    buffer_load_dwordx4 v[244:247], v4, s[20:23], s40 offen offset:1024 nt
    buffer_load_dwordx4 v[112:115], v2, s[32:35], s42 offen offset:0 sc1
    v_max3_f32 v72, v48, v49, v50
    v_max3_f32 v76, v51, v52, v53
    v_max3_f32 v72, v72, v54, v55
    v_max3_f32 v76, v76, v56, v57
    v_max3_f32 v72, v72, v58, v59
    v_max3_f32 v76, v76, v60, v61
    v_max3_f32 v72, v72, v62, v63
    v_max_f32 v72, v72, v76
    s_mov_b32 s58, 0x3fb8aa3b
    s_mov_b32 s59, 0x3fb8aa3b
    v_max_f32_dpp v72, v72, v72 row_ror:8 row_mask:0xf bank_mask:0xf
    v_mov_b32 v76, v72
    s_nop 1
    v_permlane16_swap_b32 v72, v76
    v_max_f32 v72, v72, v76
    v_mov_b32 v76, v72
    s_nop 1
    v_permlane32_swap_b32 v72, v76
    v_max_f32 v72, v72, v76
    v_mul_f32 v76, 0xbfb8aa3b, v72
    v_pk_fma_f32 v[48:49], v[48:49], s[58:59], v[76:77] op_sel_hi:[1,1,0]
    v_pk_fma_f32 v[50:51], v[50:51], s[58:59], v[76:77] op_sel_hi:[1,1,0]
    v_pk_fma_f32 v[52:53], v[52:53], s[58:59], v[76:77] op_sel_hi:[1,1,0]
    v_pk_fma_f32 v[54:55], v[54:55], s[58:59], v[76:77] op_sel_hi:[1,1,0]
    v_pk_fma_f32 v[56:57], v[56:57], s[58:59], v[76:77] op_sel_hi:[1,1,0]
    v_pk_fma_f32 v[58:59], v[58:59], s[58:59], v[76:77] op_sel_hi:[1,1,0]
    v_pk_fma_f32 v[60:61], v[60:61], s[58:59], v[76:77] op_sel_hi:[1,1,0]
    v_pk_fma_f32 v[62:63], v[62:63], s[58:59], v[76:77] op_sel_hi:[1,1,0]
    v_exp_f32 v48, v48
    v_exp_f32 v49, v49
    v_exp_f32 v50, v50
    v_exp_f32 v51, v51
    v_exp_f32 v52, v52
    v_exp_f32 v53, v53
    v_exp_f32 v54, v54
    v_exp_f32 v55, v55
    v_exp_f32 v56, v56
    v_exp_f32 v57, v57
    v_exp_f32 v58, v58
    v_exp_f32 v59, v59
    v_exp_f32 v60, v60
    v_exp_f32 v61, v61
    v_exp_f32 v62, v62
    v_exp_f32 v63, v63
    s_waitcnt vmcnt(7)
    s_add_u32 s40, s94, 32768
    s_and_b32 s40, s40, 0x1c000
    buffer_load_dwordx4 v[232:235], v4, s[20:23], s40 offen offset:2048 nt
    v_pk_add_f32 v[76:77], v[48:49], v[50:51]
    v_pk_add_f32 v[78:79], v[52:53], v[54:55]
    v_pk_add_f32 v[76:77], v[76:77], v[56:57]
    v_pk_add_f32 v[78:79], v[78:79], v[58:59]
    v_pk_add_f32 v[76:77], v[76:77], v[60:61]
    v_pk_add_f32 v[78:79], v[78:79], v[62:63]
    v_pk_add_f32 v[76:77], v[76:77], v[78:79]
    v_add_f32 v73, v76, v77
    s_nop 1
    v_add_f32_dpp v73, v73, v73 row_ror:8 row_mask:0xf bank_mask:0xf
    v_mov_b32 v76, v73
    s_nop 1
    v_permlane16_swap_b32 v73, v76
    v_add_f32 v73, v73, v76
    v_mov_b32 v76, v73
    s_nop 1
    v_permlane32_swap_b32 v73, v76
    v_add_f32 v73, v73, v76
    ds_write_b64 v12, v[72:73] offset:53504
    v_cvt_pk_bf16_f32 v48, v48, v49
    v_cvt_pk_bf16_f32 v49, v50, v51
    v_cvt_pk_bf16_f32 v50, v52, v53
    v_cvt_pk_bf16_f32 v51, v54, v55
    v_cvt_pk_bf16_f32 v52, v56, v57
    v_cvt_pk_bf16_f32 v53, v58, v59
    v_cvt_pk_bf16_f32 v54, v60, v61
    v_cvt_pk_bf16_f32 v55, v62, v63
    s_lshl3_add_u32 s58, s5, s4
    s_lshl_b32 s58, s58, 7
    s_add_u32 s43, s58, 1441792
    s_lshl_b32 s58, s3, 28
    v_add_u32 v7, s58, v8
    s_waitcnt vmcnt(7)
    s_add_u32 s40, s94, 49152
    s_and_b32 s40, s40, 0x1c000
    buffer_load_dwordx4 v[248:251], v4, s[20:23], s40 offen offset:2048 nt
    s_waitcnt lgkmcnt(0)
    s_barrier
    ds_read_b128 v[60:63], v13 offset:53504
    ds_read_b128 v[64:67], v13 offset:53520
    v_mov_b32 v74, s47
    s_waitcnt lgkmcnt(0)
    v_max3_f32 v72, v60, v62, v64
    v_max_f32 v72, v72, v66
    v_sub_f32 v68, v60, v72
    v_sub_f32 v69, v62, v72
    v_sub_f32 v70, v64, v72
    v_sub_f32 v71, v66, v72
    v_mul_f32 v68, 0x3fb8aa3b, v68
    v_mul_f32 v69, 0x3fb8aa3b, v69
    v_mul_f32 v70, 0x3fb8aa3b, v70
    v_mul_f32 v71, 0x3fb8aa3b, v71
    v_exp_f32 v68, v68
    v_exp_f32 v69, v69
    v_exp_f32 v70, v70
    v_exp_f32 v71, v71
    v_or_b32 v72, s46, v72
    v_mul_f32 v73, v68, v61
    v_fmac_f32 v73, v69, v63
    v_fmac_f32 v73, v70, v65
    v_fmac_f32 v73, v71, v67
    s_mov_b32 exec_lo, 0x01010101
    s_mov_b32 exec_hi, 0x01010101
    s_cmp_eq_u32 s57, 0
    s_cbranch_scc1 L_far_mlst
    buffer_store_dwordx4 v[72:75], v7, s[32:35], s43 offen
L_back_mlst:
    s_mov_b64 exec, -1
    v_mov_b32_dpp v16, v48 quad_perm:[0,1,2,3] row_mask:0xf bank_mask:0x3
    v_mov_b32_dpp v17, v49 quad_perm:[0,1,2,3] row_mask:0xf bank_mask:0x3
    v_mov_b32_dpp v18, v50 quad_perm:[0,1,2,3] row_mask:0xf bank_mask:0x3
    v_mov_b32_dpp v19, v51 quad_perm:[0,1,2,3] row_mask:0xf bank_mask:0x3
    v_mov_b32_dpp v20, v48 row_ror:8 row_mask:0xf bank_mask:0xc
    v_mov_b32_dpp v21, v49 row_ror:8 row_mask:0xf bank_mask:0xc
    v_mov_b32_dpp v22, v50 row_ror:8 row_mask:0xf bank_mask:0xc
    v_mov_b32_dpp v23, v51 row_ror:8 row_mask:0xf bank_mask:0xc
    s_waitcnt vmcnt(8)
    s_add_u32 s40, s94, 32768
    s_and_b32 s40, s40, 0x1c000
    buffer_load_dwordx4 v[236:239], v4, s[20:23], s40 offen offset:3072 nt
    v_perm_b32 v72, v196, v192, s44
    v_perm_b32 v73, v204, v200, s44
    v_perm_b32 v74, v212, v208, s44
    v_perm_b32 v75, v220, v216, s44
    v_perm_b32 v76, v196, v192, s45
    v_perm_b32 v77, v204, v200, s45
    v_perm_b32 v78, v212, v208, s45
    v_perm_b32 v79, v220, v216, s45
    v_mfma_f32_16x16x32_bf16 v[32:35], v[72:75], v[16:19], 0
    v_perm_b32 v80, v197, v193, s44
    v_perm_b32 v81, v205, v201, s44
    v_perm_b32 v82, v213, v209, s44
    v_perm_b32 v83, v221, v217, s44
    v_mfma_f32_16x16x32_bf16 v[36:39], v[76:79], v[16:19], 0
    v_perm_b32 v84, v197, v193, s45
    v_perm_b32 v85, v205, v201, s45
    v_perm_b32 v86, v213, v209, s45
    v_perm_b32 v87, v221, v217, s45
    v_mfma_f32_16x16x32_bf16 v[40:43], v[80:83], v[16:19], 0
    v_perm_b32 v88, v198, v194, s44
    v_perm_b32 v89, v206, v202, s44
    v_perm_b32 v90, v214, v210, s44
    v_perm_b32 v91, v222, v218, s44
    v_mfma_f32_16x16x32_bf16 v[44:47], v[84:87], v[16:19], 0
    v_perm_b32 v92, v198, v194, s45
    v_perm_b32 v93, v206, v202, s45
    v_perm_b32 v94, v214, v210, s45
    v_perm_b32 v95, v222, v218, s45
    v_mfma_f32_16x16x32_bf16 v[32:35], v[88:91], v[20:23], v[32:35]
    v_perm_b32 v96, v199, v195, s44
    v_perm_b32 v97, v207, v203, s44
    v_perm_b32 v98, v215, v211, s44
    v_perm_b32 v99, v223, v219, s44
    v_mfma_f32_16x16x32_bf16 v[36:39], v[92:95], v[20:23], v[36:39]
    v_perm_b32 v100, v199, v195, s45
    v_perm_b32 v101, v207, v203, s45
    v_perm_b32 v102, v215, v211, s45
    v_perm_b32 v103, v223, v219, s45
    v_mfma_f32_16x16x32_bf16 v[40:43], v[96:99], v[20:23], v[40:43]
    s_nop 0
    v_mfma_f32_16x16x32_bf16 v[44:47], v[100:103], v[20:23], v[44:47]
    s_lshl2_add_u32 s58, s101, s3
    s_lshl3_add_u32 s58, s58, s4
    s_lshl_b32 s58, s58, 7
    s_add_u32 s43, s58, 1179648
    s_cmp_lt_u32 s101, 28
    s_cselect_b32 s58, 0, 0x10000000
    v_add_u32 v126, s58, v126
    s_waitcnt vmcnt(8)
    s_add_u32 s40, s94, 49152
    s_and_b32 s40, s40, 0x1c000
    buffer_load_dwordx4 v[252:255], v4, s[20:23], s40 offen offset:3072 nt
    s_waitcnt vmcnt(8)
    s_add_u32 s40, s94, 65536
    s_and_b32 s40, s40, 0x1c000
    buffer_load_dwordx4 v[128:131], v4, s[20:23], s40 offen offset:0 nt
    s_waitcnt vmcnt(8)
    s_add_u32 s40, s94, 81920
    s_and_b32 s40, s40, 0x1c000
    buffer_load_dwordx4 v[144:147], v4, s[20:23], s40 offen offset:0 nt
    s_waitcnt vmcnt(8)
    s_add_u32 s40, s94, 65536
    s_and_b32 s40, s40, 0x1c000
    buffer_load_dwordx4 v[132:135], v4, s[20:23], s40 offen offset:1024 nt
L_chk_gu:
    s_waitcnt vmcnt(8)
    v_xor_b32 v112, s12, v112
    v_xor_b32 v114, s13, v114
    v_or_b32 v15, v112, v114
    v_and_b32 v15, 0xff, v15
    v_cmp_ne_u32 vcc, 0, v15
    s_nop 0
    s_cbranch_vccnz L_retry_gu
L_ok_gu:
    v_add_f32_dpp v104, v113, v113 row_ror:8 row_mask:0xf bank_mask:0xc
    v_add_f32_dpp v105, v115, v115 row_ror:8 row_mask:0xf bank_mask:0xc
    s_nop 0
    v_add_f32_dpp v104, v112, v112 row_ror:8 row_mask:0xf bank_mask:0x3
    v_add_f32_dpp v105, v114, v114 row_ror:8 row_mask:0xf bank_mask:0x3
    s_nop 1
    v_permlane16_swap_b32 v104, v105
    v_add_f32 v104, v104, v105
    v_cvt_pk_bf16_f32 v104, v104, v104
    v_and_b32 v104, s51, v104
    v_mov_b32 v105, v104
    s_nop 1
    v_permlane32_swap_b32 v104, v105
    v_mul_f32 v104, v104, v105
    v_cvt_pk_bf16_f32 v104, v104, v104
    v_and_or_b32 v104, v104, s51, v6
    s_nop 1
    v_mov_b32_dpp v105, v104 quad_perm:[1,1,1,1] row_mask:0xf bank_mask:0xf
    v_mov_b32_dpp v106, v104 quad_perm:[2,2,2,2] row_mask:0xf bank_mask:0xf
    v_mov_b32_dpp v107, v104 quad_perm:[3,3,3,3] row_mask:0xf bank_mask:0xf
    s_mov_b64 exec, 0x11111111
    buffer_store_dwordx4 v[104:107], v126, s[32:35], s43 offen sc1
    s_mov_b64 exec, -1
    v_mov_b32_dpp v16, v48 row_ror:8 row_mask:0xf bank_mask:0x3
    v_mov_b32_dpp v17, v49 row_ror:8 row_mask:0xf bank_mask:0x3
    v_mov_b32_dpp v18, v50 row_ror:8 row_mask:0xf bank_mask:0x3
    v_mov_b32_dpp v19, v51 row_ror:8 row_mask:0xf bank_mask:0x3
    v_mov_b32_dpp v20, v48 quad_perm:[0,1,2,3] row_mask:0xf bank_mask:0xc
    v_mov_b32_dpp v21, v49 quad_perm:[0,1,2,3] row_mask:0xf bank_mask:0xc
    v_mov_b32_dpp v22, v50 quad_perm:[0,1,2,3] row_mask:0xf bank_mask:0xc
    v_mov_b32_dpp v23, v51 quad_perm:[0,1,2,3] row_mask:0xf bank_mask:0xc
    v_and_b32 v12, 15, v1
    s_lshl_b32 s59, s56, 8
    v_lshl_add_u32 v12, v12, 4, s59
    v_lshrrev_b32 v13, 4, v1
    s_lshl_b32 s58, s50, 7
    s_add_u32 s58, s58, s3
    v_lshl_add_u32 v7, v13, 5, s58
    v_lshl_add_u32 v7, v7, 11, v12
    s_lshl_b32 s58, s98, 7
    s_add_u32 s58, s58, s3
    v_lshl_add_u32 v123, v13, 3, s58
    v_lshl_add_u32 v123, v123, 11, v12
    s_lshr_b32 s58, s50, 2
    s_lshl_b32 s58, s58, 11
    s_add_u32 s58, s58, s59
    s_and_b32 s59, s50, 3
    s_lshl_b32 s59, s59, 6
    s_add_u32 s58, s58, s59
    v_and_b32 v12, 31, v1
    v_lshl_add_u32 v3, v12, 1, s58
    v_and_b32 v12, 7, v1
    v_lshl_add_u32 v3, v12, 1, s58
    v_and_b32 v13, 48, v1
    v_add_u32 v3, v3, v13
    buffer_load_ushort v14, v3, s[8:11], 0 offen
    s_waitcnt vmcnt(9)
    s_add_u32 s40, s94, 81920
    s_and_b32 s40, s40, 0x1c000
    buffer_load_dwordx4 v[148:151], v4, s[20:23], s40 offen offset:1024 nt
    v_lshrrev_b32 v12, 3, v1
    s_and_b32 s58, s3, 1
    s_lshl_b32 s58, s58, 2
    v_xor_b32 v12, s58, v12
    v_and_b32 v13, 4, v1
    v_lshl_add_u32 v12, v13, 1, v12
    s_lshl_b32 s58, s3, 8
    v_lshl_add_u32 v12, v12, 4, s58
    v_and_b32 v13, 3, v1
    v_mul_u32_u24 v13, 1088, v13
    v_add_u32 v12, v12, v13
    s_mov_b32 s43, s42
    s_lshl2_add_u32 s58, s50, s3
    s_lshl_b32 s58, s58, 10
    s_add_u32 s6, s58, 1310720
    s_and_b32 s58, s2, 7
    s_lshl_b32 s59, s58, 7
    s_add_u32 s54, s6, s59
    s_sub_u32 s54, s54, 28672
    s_lshl_b32 s58, s58, 15
    s_and_b32 s59, s50, 3
    s_lshl_b32 s59, s59, 10
    s_add_u32 s58, s58, s59
    s_lshr_b32 s59, s50, 2
    s_lshl_b32 s59, s59, 7
    s_add_u32 s58, s58, s59
    s_add_u32 s7, s58, 2097152
    s_add_u32 s55, s7, 262144
    s_add_u32 s52, s7, 524288
    s_add_u32 s53, s7, 786432
    s_lshl2_add_u32 s58, s98, s3
    s_lshl_b32 s58, s58, 10
    s_add_u32 s41, s58, 1179648
    s_lshl_b32 s58, s5, 10
    s_add_u32 s58, s58, 1441792
    s_mov_b32 s96, s41
    s_mov_b32 s41, s58
    s_lshl2_add_u32 s58, s99, s3
    s_lshl_b32 s58, s58, 10
    s_add_u32 s54, s58, 1048576
    s_and_b32 s58, s58, 0x3fff
    s_lshl_b32 s59, s4, 7
    s_add_u32 s58, s58, s59
    s_add_u32 s6, s58, 1048576
    v_and_b32 v124, 7, v1
    v_and_b32 v125, 0x70, v8
    v_lshl_add_u32 v122, v124, 14, v125
    s_and_b32 s58, s2, 7
    v_and_b32 v125, 7, v1
    v_cmp_eq_u32 vcc, s58, v125
    s_sub_u32 s59, s42, s6
    v_lshrrev_b32 v125, 3, v1
    v_lshl_add_u32 v125, v125, 4, s59
    v_cndmask_b32 v124, v122, v125, vcc
    s_add_u32 s12, s46, 32
    s_and_b32 s12, s12, 0xff
    s_add_u32 s13, s47, 32
    s_and_b32 s13, s13, 0xff
    s_waitcnt vmcnt(9)
    s_add_u32 s40, s94, 65536
    s_and_b32 s40, s40, 0x1c000
    buffer_load_dwordx4 v[136:139], v4, s[20:23], s40 offen offset:2048 nt
    s_waitcnt vmcnt(8)
    s_add_u32 s40, s94, 81920
    s_and_b32 s40, s40, 0x1c000
    buffer_load_dwordx4 v[152:155], v4, s[20:23], s40 offen offset:2048 nt
    s_waitcnt vmcnt(8)
    s_add_u32 s40, s94, 65536
    s_and_b32 s40, s40, 0x1c000
    buffer_load_dwordx4 v[140:143], v4, s[20:23], s40 offen offset:3072 nt
    v_perm_b32 v72, v228, v224, s44
    v_perm_b32 v73, v236, v232, s44
    v_perm_b32 v74, v244, v240, s44
    v_perm_b32 v75, v252, v248, s44
    v_perm_b32 v76, v228, v224, s45
    v_perm_b32 v77, v236, v232, s45
    v_perm_b32 v78, v244, v240, s45
    v_perm_b32 v79, v252, v248, s45
    v_mfma_f32_16x16x32_bf16 v[32:35], v[72:75], v[16:19], v[32:35]
    v_perm_b32 v80, v229, v225, s44
    v_perm_b32 v81, v237, v233, s44
    v_perm_b32 v82, v245, v241, s44
    v_perm_b32 v83, v253, v249, s44
    v_mfma_f32_16x16x32_bf16 v[36:39], v[76:79], v[16:19], v[36:39]
    v_perm_b32 v84, v229, v225, s45
    v_perm_b32 v85, v237, v233, s45
    v_perm_b32 v86, v245, v241, s45
    v_perm_b32 v87, v253, v249, s45
    v_mfma_f32_16x16x32_bf16 v[40:43], v[80:83], v[16:19], v[40:43]
    v_perm_b32 v88, v230, v226, s44
    v_perm_b32 v89, v238, v234, s44
    v_perm_b32 v90, v246, v242, s44
    v_perm_b32 v91, v254, v250, s44
    v_mfma_f32_16x16x32_bf16 v[44:47], v[84:87], v[16:19], v[44:47]
    v_perm_b32 v92, v230, v226, s45
    v_perm_b32 v93, v238, v234, s45
    v_perm_b32 v94, v246, v242, s45
    v_perm_b32 v95, v254, v250, s45
    v_mfma_f32_16x16x32_bf16 v[32:35], v[88:91], v[20:23], v[32:35]
    v_perm_b32 v96, v231, v227, s44
    v_perm_b32 v97, v239, v235, s44
    v_perm_b32 v98, v247, v243, s44
    v_perm_b32 v99, v255, v251, s44
    v_mfma_f32_16x16x32_bf16 v[36:39], v[92:95], v[20:23], v[36:39]
    v_perm_b32 v100, v231, v227, s45
    v_perm_b32 v101, v239, v235, s45
    v_perm_b32 v102, v247, v243, s45
    v_perm_b32 v103, v255, v251, s45
    v_mfma_f32_16x16x32_bf16 v[40:43], v[96:99], v[20:23], v[40:43]
    s_nop 0
    v_mfma_f32_16x16x32_bf16 v[44:47], v[100:103], v[20:23], v[44:47]
    v_mov_b32_dpp v16, v52 quad_perm:[0,1,2,3] row_mask:0xf bank_mask:0x3
    v_mov_b32_dpp v17, v53 quad_perm:[0,1,2,3] row_mask:0xf bank_mask:0x3
    v_mov_b32_dpp v18, v54 quad_perm:[0,1,2,3] row_mask:0xf bank_mask:0x3
    v_mov_b32_dpp v19, v55 quad_perm:[0,1,2,3] row_mask:0xf bank_mask:0x3
    v_mov_b32_dpp v20, v52 row_ror:8 row_mask:0xf bank_mask:0xc
    v_mov_b32_dpp v21, v53 row_ror:8 row_mask:0xf bank_mask:0xc
    v_mov_b32_dpp v22, v54 row_ror:8 row_mask:0xf bank_mask:0xc
    v_mov_b32_dpp v23, v55 row_ror:8 row_mask:0xf bank_mask:0xc
L_fork:
    s_cmp_eq_u32 s4, 7
    s_cbranch_scc1 L_R
    s_waitcnt vmcnt(8)
    s_add_u32 s40, s94, 81920
    s_and_b32 s40, s40, 0x1c000
    buffer_load_dwordx4 v[156:159], v4, s[20:23], s40 offen offset:3072 nt
    s_waitcnt vmcnt(7)
    s_add_u32 s40, s94, 98304
    s_and_b32 s40, s40, 0x1c000
    buffer_load_dwordx4 v[160:163], v4, s[20:23], s40 offen offset:0 nt
    s_waitcnt vmcnt(5)
    s_add_u32 s40, s94, 114688
    s_and_b32 s40, s40, 0x1c000
    buffer_load_dwordx4 v[176:179], v4, s[20:23], s40 offen offset:0 nt
    s_waitcnt vmcnt(5)
    s_add_u32 s40, s94, 98304
    s_and_b32 s40, s40, 0x1c000
    buffer_load_dwordx4 v[164:167], v4, s[20:23], s40 offen offset:1024 nt
    s_waitcnt vmcnt(5)
    s_add_u32 s40, s94, 114688
    s_and_b32 s40, s40, 0x1c000
    buffer_load_dwordx4 v[180:183], v4, s[20:23], s40 offen offset:1024 nt
    s_waitcnt vmcnt(5)
    s_add_u32 s40, s94, 98304
    s_and_b32 s40, s40, 0x1c000
    buffer_load_dwordx4 v[168:171], v4, s[20:23], s40 offen offset:2048 nt
    s_waitcnt vmcnt(5)
    buffer_load_dwordx4 v[172:175], v4, s[20:23], s40 offen offset:3072 nt
    v_perm_b32 v72, v132, v128, s44
    v_perm_b32 v73, v140, v136, s44
    v_perm_b32 v74, v148, v144, s44
    v_perm_b32 v75, v156, v152, s44
    v_perm_b32 v76, v132, v128, s45
    v_perm_b32 v77, v140, v136, s45
    v_perm_b32 v78, v148, v144, s45
    v_perm_b32 v79, v156, v152, s45
    v_mfma_f32_16x16x32_bf16 v[32:35], v[72:75], v[16:19], v[32:35]
    v_perm_b32 v80, v133, v129, s44
    v_perm_b32 v81, v141, v137, s44
    v_perm_b32 v82, v149, v145, s44
    v_perm_b32 v83, v157, v153, s44
    v_mfma_f32_16x16x32_bf16 v[36:39], v[76:79], v[16:19], v[36:39]
    v_perm_b32 v84, v133, v129, s45
    v_perm_b32 v85, v141, v137, s45
    v_perm_b32 v86, v149, v145, s45
    v_perm_b32 v87, v157, v153, s45
    v_mfma_f32_16x16x32_bf16 v[40:43], v[80:83], v[16:19], v[40:43]
    v_perm_b32 v88, v134, v130, s44
    v_perm_b32 v89, v142, v138, s44
    v_perm_b32 v90, v150, v146, s44
    v_perm_b32 v91, v158, v154, s44
    v_mfma_f32_16x16x32_bf16 v[44:47], v[84:87], v[16:19], v[44:47]
    v_perm_b32 v92, v134, v130, s45
    v_perm_b32 v93, v142, v138, s45
    v_perm_b32 v94, v150, v146, s45
    v_perm_b32 v95, v158, v154, s45
    v_mfma_f32_16x16x32_bf16 v[32:35], v[88:91], v[20:23], v[32:35]
    v_perm_b32 v96, v135, v131, s44
    v_perm_b32 v97, v143, v139, s44
    v_perm_b32 v98, v151, v147, s44
    v_perm_b32 v99, v159, v155, s44
    v_mfma_f32_16x16x32_bf16 v[36:39], v[92:95], v[20:23], v[36:39]
    v_perm_b32 v100, v135, v131, s45
    v_perm_b32 v101, v143, v139, s45
    v_perm_b32 v102, v151, v147, s45
    v_perm_b32 v103, v159, v155, s45
    v_mfma_f32_16x16x32_bf16 v[40:43], v[96:99], v[20:23], v[40:43]
    s_nop 0
    v_mfma_f32_16x16x32_bf16 v[44:47], v[100:103], v[20:23], v[44:47]
    v_mov_b32_dpp v16, v52 row_ror:8 row_mask:0xf bank_mask:0x3
    v_mov_b32_dpp v17, v53 row_ror:8 row_mask:0xf bank_mask:0x3
    v_mov_b32_dpp v18, v54 row_ror:8 row_mask:0xf bank_mask:0x3
    v_mov_b32_dpp v19, v55 row_ror:8 row_mask:0xf bank_mask:0x3
    v_mov_b32_dpp v20, v52 quad_perm:[0,1,2,3] row_mask:0xf bank_mask:0xc
    v_mov_b32_dpp v21, v53 quad_perm:[0,1,2,3] row_mask:0xf bank_mask:0xc
    v_mov_b32_dpp v22, v54 quad_perm:[0,1,2,3] row_mask:0xf bank_mask:0xc
    v_mov_b32_dpp v23, v55 quad_perm:[0,1,2,3] row_mask:0xf bank_mask:0xc
    s_waitcnt vmcnt(5)
    s_add_u32 s40, s94, 114688
    s_and_b32 s40, s40, 0x1c000
    buffer_load_dwordx4 v[184:187], v4, s[20:23], s40 offen offset:2048 nt
    s_waitcnt vmcnt(5)
    buffer_load_dwordx4 v[188:191], v4, s[20:23], s40 offen offset:3072 nt
    s_waitcnt vmcnt(5)
    buffer_load_dwordx4 v[192:195], v123, s[24:27], 0 offen offset:0 nt
    v_perm_b32 v72, v164, v160, s44
    v_perm_b32 v76, v164, v160, s45
    v_perm_b32 v80, v165, v161, s44
    v_perm_b32 v84, v165, v161, s45
    v_perm_b32 v88, v166, v162, s44
    v_perm_b32 v92, v166, v162, s45
    v_perm_b32 v96, v167, v163, s44
    v_perm_b32 v100, v167, v163, s45
    s_waitcnt vmcnt(5)
    s_movk_i32 s40, 8192
    buffer_load_dwordx4 v[196:199], v123, s[24:27], s40 offen offset:0 nt
    v_perm_b32 v74, v180, v176, s44
    v_perm_b32 v78, v180, v176, s45
    v_perm_b32 v82, v181, v177, s44
    v_perm_b32 v86, v181, v177, s45
    v_perm_b32 v90, v182, v178, s44
    v_perm_b32 v94, v182, v178, s45
    v_perm_b32 v98, v183, v179, s44
    v_perm_b32 v102, v183, v179, s45
    s_waitcnt vmcnt(5)
    s_mov_b32 s40, 65536
    buffer_load_dwordx4 v[200:203], v123, s[24:27], s40 offen offset:0 nt
    s_waitcnt vmcnt(5)
    s_mov_b32 s40, 73728
    buffer_load_dwordx4 v[204:207], v123, s[24:27], s40 offen offset:0 nt
    v_perm_b32 v73, v172, v168, s44
    v_perm_b32 v77, v172, v168, s45
    v_perm_b32 v81, v173, v169, s44
    v_perm_b32 v85, v173, v169, s45
    v_perm_b32 v89, v174, v170, s44
    v_perm_b32 v93, v174, v170, s45
    v_perm_b32 v97, v175, v171, s44
    v_perm_b32 v101, v175, v171, s45
    s_waitcnt vmcnt(4)
    v_perm_b32 v75, v188, v184, s44
    v_perm_b32 v91, v190, v186, s44
    v_perm_b32 v79, v188, v184, s45
    v_mfma_f32_16x16x32_bf16 v[32:35], v[72:75], v[16:19], v[32:35]
    v_perm_b32 v95, v190, v186, s45
    v_mfma_f32_16x16x32_bf16 v[32:35], v[88:91], v[20:23], v[32:35]
    v_perm_b32 v83, v189, v185, s44
    v_mfma_f32_16x16x32_bf16 v[36:39], v[76:79], v[16:19], v[36:39]
    v_perm_b32 v99, v191, v187, s44
    v_mfma_f32_16x16x32_bf16 v[36:39], v[92:95], v[20:23], v[36:39]
    v_perm_b32 v87, v189, v185, s45
    v_mfma_f32_16x16x32_bf16 v[40:43], v[80:83], v[16:19], v[40:43]
    v_perm_b32 v103, v191, v187, s45
    v_mfma_f32_16x16x32_bf16 v[40:43], v[96:99], v[20:23], v[40:43]
    v_mfma_f32_16x16x32_bf16 v[44:47], v[84:87], v[16:19], v[44:47]
    ds_write_b128 v9, v[32:35] offset:0
    v_mfma_f32_16x16x32_bf16 v[44:47], v[100:103], v[20:23], v[44:47]
    s_nop 0
    ds_write_b128 v9, v[36:39] offset:1088
    s_nop 2
    ds_write_b128 v9, v[40:43] offset:2176
    s_nop 1
    ds_write_b128 v9, v[44:47] offset:3264
    s_waitcnt lgkmcnt(0)
    s_barrier
    ds_read_b128 v[104:107], v10 offset:0
    ds_read_b128 v[108:111], v10 offset:4352
    ds_read_b128 v[112:115], v10 offset:8704
    ds_read_b128 v[116:119], v10 offset:13056
    s_waitcnt lgkmcnt(3)
    v_pk_mul_f32 v[104:105], v[104:105], v[68:69] op_sel:[0,0] op_sel_hi:[1,0]
    v_pk_mul_f32 v[106:107], v[106:107], v[68:69] op_sel:[0,0] op_sel_hi:[1,0]
    s_waitcnt lgkmcnt(2)
    v_pk_fma_f32 v[104:105], v[108:109], v[68:69], v[104:105] op_sel:[0,1,0] op_sel_hi:[1,1,1]
    v_pk_fma_f32 v[106:107], v[110:111], v[68:69], v[106:107] op_sel:[0,1,0] op_sel_hi:[1,1,1]
    s_waitcnt lgkmcnt(1)
    v_pk_fma_f32 v[104:105], v[112:113], v[70:71], v[104:105] op_sel:[0,0,0] op_sel_hi:[1,0,1]
    v_pk_fma_f32 v[106:107], v[114:115], v[70:71], v[106:107] op_sel:[0,0,0] op_sel_hi:[1,0,1]
    s_waitcnt lgkmcnt(0)
    v_pk_fma_f32 v[104:105], v[116:117], v[70:71], v[104:105] op_sel:[0,1,0] op_sel_hi:[1,1,1]
    v_pk_fma_f32 v[106:107], v[118:119], v[70:71], v[106:107] op_sel:[0,1,0] op_sel_hi:[1,1,1]
    v_and_or_b32 v104, v104, v11, s12
    v_and_or_b32 v106, v106, v11, s13
    s_cmp_eq_u32 s57, 0
    s_cbranch_scc1 L_far_ost
    buffer_store_dwordx4 v[104:107], v2, s[32:35], s43 offen
L_back_ost:
    s_barrier
    s_mov_b32 s40, 131072
    buffer_load_dwordx4 v[208:211], v123, s[24:27], s40 offen offset:0 nt
    s_mov_b32 s40, 139264
    buffer_load_dwordx4 v[212:215], v123, s[24:27], s40 offen offset:0 nt
    s_waitcnt vmcnt(6)
    s_mov_b32 s40, 196608
    buffer_load_dwordx4 v[216:219], v123, s[24:27], s40 offen offset:0 nt
    s_waitcnt vmcnt(6)
    s_mov_b32 s40, 204800
    buffer_load_dwordx4 v[220:223], v123, s[24:27], s40 offen offset:0 nt
    s_waitcnt vmcnt(6)
    buffer_load_dwordx4 v[224:227], v7, s[28:31], 0 offen offset:0 nt
    s_waitcnt vmcnt(6)
    s_movk_i32 s40, 8192
    buffer_load_dwordx4 v[240:243], v7, s[28:31], s40 offen offset:0 nt
    s_waitcnt vmcnt(5)
    s_movk_i32 s40, 16384
    buffer_load_dwordx4 v[228:231], v7, s[28:31], s40 offen offset:0 nt
    s_waitcnt vmcnt(5)
    s_movk_i32 s40, 24576
    buffer_load_dwordx4 v[244:247], v7, s[28:31], s40 offen offset:0 nt
    buffer_load_dwordx4 v[128:131], v8, s[32:35], s96 offen offset:0 sc1
    s_waitcnt vmcnt(6)
    s_mov_b32 s40, 32768
    buffer_load_dwordx4 v[232:235], v7, s[28:31], s40 offen offset:0 nt
    s_waitcnt vmcnt(6)
    s_mov_b32 s40, 40960
    buffer_load_dwordx4 v[248:251], v7, s[28:31], s40 offen offset:0 nt
    s_waitcnt vmcnt(6)
    s_mov_b32 s40, 49152
    buffer_load_dwordx4 v[236:239], v7, s[28:31], s40 offen offset:0 nt
    s_waitcnt vmcnt(6)
    s_mov_b32 s40, 57344
    buffer_load_dwordx4 v[252:255], v7, s[28:31], s40 offen offset:0 nt
    buffer_load_dwordx4 v[104:107], v124, s[32:35], s6 offen offset:0 sc1
    s_add_u32 s12, s46, 64
    s_and_b32 s12, s12, 0xff
    s_add_u32 s13, s47, 64
    s_and_b32 s13, s13, 0xff
L_chk_h:
    s_waitcnt vmcnt(5)
    v_xor_b32 v128, s46, v128
    v_xor_b32 v130, s47, v130
    v_or_b32 v15, v128, v130
    v_and_b32 v15, 0xff, v15
    v_cmp_ne_u32 vcc, 0, v15
    s_nop 0
    s_cbranch_vccnz L_retry_h
L_ok_h:
    v_perm_b32 v128, v129, v128, s45
    v_perm_b32 v129, v131, v130, s45
    s_nop 0
    v_mov_b32_dpp v24, v128 quad_perm:[0,1,2,3] row_mask:0xf bank_mask:0x3
    v_mov_b32_dpp v26, v128 row_ror:8 row_mask:0xf bank_mask:0x3
    v_mov_b32_dpp v25, v129 quad_perm:[0,1,2,3] row_mask:0xf bank_mask:0x3
    v_mov_b32_dpp v27, v129 row_ror:8 row_mask:0xf bank_mask:0x3
    v_mov_b32_dpp v28, v128 row_ror:8 row_mask:0xf bank_mask:0xc
    v_mov_b32_dpp v30, v128 quad_perm:[0,1,2,3] row_mask:0xf bank_mask:0xc
    v_mov_b32_dpp v29, v129 row_ror:8 row_mask:0xf bank_mask:0xc
    v_mov_b32_dpp v31, v129 quad_perm:[0,1,2,3] row_mask:0xf bank_mask:0xc
    v_perm_b32 v72, v196, v192, s44
    v_perm_b32 v73, v204, v200, s44
    v_perm_b32 v74, v212, v208, s44
    v_perm_b32 v75, v220, v216, s44
    v_perm_b32 v76, v196, v192, s45
    v_perm_b32 v77, v204, v200, s45
    v_perm_b32 v78, v212, v208, s45
    v_perm_b32 v79, v220, v216, s45
    v_mfma_f32_16x16x32_bf16 v[48:51], v[72:75], v[24:27], 0
    v_perm_b32 v80, v197, v193, s44
    v_perm_b32 v81, v205, v201, s44
    v_perm_b32 v82, v213, v209, s44
    v_perm_b32 v83, v221, v217, s44
    v_mfma_f32_16x16x32_bf16 v[52:55], v[76:79], v[24:27], 0
    v_perm_b32 v84, v197, v193, s45
    v_perm_b32 v85, v205, v201, s45
    v_perm_b32 v86, v213, v209, s45
    v_perm_b32 v87, v221, v217, s45
    v_mfma_f32_16x16x32_bf16 v[56:59], v[80:83], v[24:27], 0
    v_perm_b32 v88, v198, v194, s44
    v_perm_b32 v89, v206, v202, s44
    v_perm_b32 v90, v214, v210, s44
    v_perm_b32 v91, v222, v218, s44
    v_mfma_f32_16x16x32_bf16 v[60:63], v[84:87], v[24:27], 0
    v_perm_b32 v92, v198, v194, s45
    v_perm_b32 v93, v206, v202, s45
    v_perm_b32 v94, v214, v210, s45
    v_perm_b32 v95, v222, v218, s45
    v_mfma_f32_16x16x32_bf16 v[48:51], v[88:91], v[28:31], v[48:51]
    v_perm_b32 v96, v199, v195, s44
    v_perm_b32 v97, v207, v203, s44
    v_perm_b32 v98, v215, v211, s44
    v_perm_b32 v99, v223, v219, s44
    v_mfma_f32_16x16x32_bf16 v[52:55], v[92:95], v[28:31], v[52:55]
    v_perm_b32 v100, v199, v195, s45
    v_perm_b32 v101, v207, v203, s45
    v_perm_b32 v102, v215, v211, s45
    v_perm_b32 v103, v223, v219, s45
    v_mfma_f32_16x16x32_bf16 v[56:59], v[96:99], v[28:31], v[56:59]
    s_nop 0
    v_mfma_f32_16x16x32_bf16 v[60:63], v[100:103], v[28:31], v[60:63]
    v_perm_b32 v72, v228, v224, s44
    v_perm_b32 v76, v228, v224, s45
    v_perm_b32 v80, v229, v225, s44
    v_perm_b32 v84, v229, v225, s45
    v_perm_b32 v88, v230, v226, s44
    v_perm_b32 v92, v230, v226, s45
    v_perm_b32 v96, v231, v227, s44
    v_perm_b32 v100, v231, v227, s45
    v_perm_b32 v74, v244, v240, s44
    v_perm_b32 v78, v244, v240, s45
    v_perm_b32 v82, v245, v241, s44
    v_perm_b32 v86, v245, v241, s45
    v_perm_b32 v90, v246, v242, s44
    v_perm_b32 v94, v246, v242, s45
    v_perm_b32 v98, v247, v243, s44
    v_perm_b32 v102, v247, v243, s45
    s_waitcnt vmcnt(2)
    v_perm_b32 v73, v236, v232, s44
    v_perm_b32 v77, v236, v232, s45
    v_perm_b32 v81, v237, v233, s44
    v_perm_b32 v85, v237, v233, s45
    v_perm_b32 v89, v238, v234, s44
    v_perm_b32 v93, v238, v234, s45
    v_perm_b32 v97, v239, v235, s44
    v_perm_b32 v101, v239, v235, s45
    s_waitcnt vmcnt(1)
    v_perm_b32 v75, v252, v248, s44
    v_perm_b32 v79, v252, v248, s45
    v_perm_b32 v83, v253, v249, s44
    v_perm_b32 v87, v253, v249, s45
    v_perm_b32 v91, v254, v250, s44
    v_perm_b32 v95, v254, v250, s45
    v_perm_b32 v99, v255, v251, s44
    v_perm_b32 v103, v255, v251, s45
L_join:
    s_lshl_b32 s58, s47, 8
    s_or_b32 s58, s58, s46
    s_mov_b32 s59, 0x0c0c0400
    s_xor_b32 s58, 0x8080, s58
    s_branch L_chk_o2
L_retry_o2:
    s_cmp_eq_u32 s48, 0
    s_cbranch_scc1 L_ok_o2
    s_sub_u32 s48, s48, 1
    buffer_load_dwordx4 v[104:107], v124, s[32:35], s6 offen offset:0 sc1
L_chk_o2:
    s_waitcnt vmcnt(0)
    v_perm_b32 v15, v106, v104, s59
    v_perm_b32 v108, v105, v104, s45
    v_cmp_ne_u32 vcc, s58, v15
    v_perm_b32 v109, v107, v106, s45
    v_mov_b32_dpp v16, v108 quad_perm:[0,1,2,3] row_mask:0xf bank_mask:0x3
    v_mov_b32_dpp v18, v108 row_ror:8 row_mask:0xf bank_mask:0x3
    v_mov_b32_dpp v17, v109 quad_perm:[0,1,2,3] row_mask:0xf bank_mask:0x3
    v_mov_b32_dpp v19, v109 row_ror:8 row_mask:0xf bank_mask:0x3
    s_cbranch_vccnz L_retry_o2
L_ok_o2:
    s_nop 1
    v_mov_b32_dpp v20, v108 row_ror:8 row_mask:0xf bank_mask:0xc
    v_mfma_f32_16x16x32_bf16 v[48:51], v[72:75], v[16:19], v[48:51]
    v_mov_b32_dpp v21, v109 row_ror:8 row_mask:0xf bank_mask:0xc
    v_mov_b32_dpp v22, v108 quad_perm:[0,1,2,3] row_mask:0xf bank_mask:0xc
    v_mfma_f32_16x16x32_bf16 v[52:55], v[76:79], v[16:19], v[52:55]
    v_mov_b32_dpp v23, v109 quad_perm:[0,1,2,3] row_mask:0xf bank_mask:0xc
    v_mfma_f32_16x16x32_bf16 v[56:59], v[80:83], v[16:19], v[56:59]
    s_nop 0
    v_mfma_f32_16x16x32_bf16 v[48:51], v[88:91], v[20:23], v[48:51]
    v_mfma_f32_16x16x32_bf16 v[52:55], v[92:95], v[20:23], v[52:55]
    v_mfma_f32_16x16x32_bf16 v[60:63], v[84:87], v[16:19], v[60:63]
    v_mfma_f32_16x16x32_bf16 v[56:59], v[96:99], v[20:23], v[56:59]
    v_mfma_f32_16x16x32_bf16 v[60:63], v[100:103], v[20:23], v[60:63]
    s_nop 3
    ds_write_b128 v9, v[48:51] offset:17408
    ds_write_b128 v9, v[52:55] offset:18496
    s_nop 0
    ds_write_b128 v9, v[56:59] offset:19584
    ds_write_b128 v9, v[60:63] offset:20672
L_bar:
    s_waitcnt lgkmcnt(0)
    s_barrier
    ds_read_b128 v[32:35], v12 offset:17408
    ds_read_b128 v[36:39], v12 offset:21760
    ds_read_b128 v[40:43], v12 offset:26112
    ds_read_b128 v[44:47], v12 offset:30464
    s_waitcnt lgkmcnt(2)
    v_pk_add_f32 v[32:33], v[32:33], v[36:37]
    v_pk_add_f32 v[34:35], v[34:35], v[38:39]
    s_waitcnt lgkmcnt(0)
    v_pk_add_f32 v[40:41], v[40:41], v[44:45]
    v_pk_add_f32 v[42:43], v[42:43], v[46:47]
    v_pk_add_f32 v[32:33], v[32:33], v[40:41]
    v_pk_add_f32 v[34:35], v[34:35], v[42:43]
    v_and_or_b32 v32, v32, v11, s12
    v_and_or_b32 v34, v34, v11, s13
    s_cmp_eq_u32 s57, 0
    s_cbranch_scc1 L_far_fst
    buffer_store_dwordx4 v[32:35], v2, s[32:35], s43 offen
L_back_fst:
    s_cmp_lg_u32 s3, 0
    s_cbranch_scc1 L_fin
    buffer_load_dwordx4 v[160:163], v127, s[32:35], s7 offen offset:0 sc1
    buffer_load_dwordx4 v[164:167], v127, s[32:35], s55 offen offset:0 sc1
    buffer_load_dwordx4 v[168:171], v127, s[32:35], s52 offen offset:0 sc1
    buffer_load_dwordx4 v[172:175], v127, s[32:35], s53 offen offset:0 sc1
    v_lshlrev_b32 v14, 16, v14
    s_movk_i32 s58, 0xff
    s_branch L_chk_f
L_retry_f:
    s_cmp_eq_u32 s48, 0
    s_cbranch_scc1 L_ok_f
    s_sub_u32 s48, s48, 1
    buffer_load_dwordx4 v[160:163], v127, s[32:35], s7 offen offset:0 sc1
    buffer_load_dwordx4 v[164:167], v127, s[32:35], s55 offen offset:0 sc1
    buffer_load_dwordx4 v[168:171], v127, s[32:35], s52 offen offset:0 sc1
    buffer_load_dwordx4 v[172:175], v127, s[32:35], s53 offen offset:0 sc1
L_chk_f:
    s_waitcnt vmcnt(3)
    v_xor_b32 v160, s12, v160
    v_xor_b32 v162, s13, v162
    v_or_b32 v15, v160, v162
    s_waitcnt vmcnt(2)
    v_xor_b32 v164, s12, v164
    v_xor_b32 v166, s13, v166
    v_or3_b32 v15, v15, v164, v166
    v_pk_add_f32 v[160:161], v[160:161], v[164:165]
    v_pk_add_f32 v[162:163], v[162:163], v[166:167]
    s_waitcnt vmcnt(1)
    v_xor_b32 v168, s12, v168
    v_xor_b32 v170, s13, v170
    v_or3_b32 v15, v15, v168, v170
    v_pk_add_f32 v[160:161], v[160:161], v[168:169]
    v_pk_add_f32 v[162:163], v[162:163], v[170:171]
    s_waitcnt vmcnt(0)
    v_xor_b32 v172, s12, v172
    v_xor_b32 v174, s13, v174
    v_or3_b32 v15, v15, v172, v174
    v_and_b32 v15, s58, v15
    v_cmp_ne_u32 vcc, 0, v15
    v_pk_add_f32 v[160:161], v[160:161], v[172:173]
    v_pk_add_f32 v[162:163], v[162:163], v[174:175]
    s_nop 1
    v_permlane32_swap_b32 v160, v162
    v_permlane32_swap_b32 v161, v163
    v_pk_add_f32 v[160:161], v[160:161], v[162:163]
    s_cbranch_vccnz L_retry_f
L_ok_f:
    s_nop 0
    v_permlane16_swap_b32 v160, v161
    v_add_f32 v160, v160, v161
    s_nop 1
    v_add_f32_dpp v160, v160, v160 row_ror:8 row_mask:0xf bank_mask:0xf
    v_add_f32 v160, v160, v14
    s_mov_b32 exec_lo, 0x00ff00ff
    s_mov_b32 exec_hi, 0x00ff00ff
    v_cvt_pk_bf16_f32 v160, v160, v160
    buffer_store_short v160, v3, s[36:39], 0 offen
    s_cmp_lg_u32 s2, 0
    s_cbranch_scc1 L_fin
    s_mov_b64 exec, 1
    v_mov_b32 v161, s1
    buffer_store_dword v161, off, s[32:35], 0
L_fin:
    s_endpgm
L_R:
    s_waitcnt vmcnt(8)
    s_add_u32 s40, s94, 81920
    s_and_b32 s40, s40, 0x1c000
    buffer_load_dwordx4 v[156:159], v4, s[20:23], s40 offen offset:3072 nt
    s_waitcnt vmcnt(8)
    s_add_u32 s40, s94, 98304
    s_and_b32 s40, s40, 0x1c000
    buffer_load_dwordx4 v[160:163], v4, s[20:23], s40 offen offset:0 nt
    buffer_load_dwordx4 v[108:111], v8, s[32:35], s41 offen offset:0 sc1
    s_waitcnt vmcnt(9)
    s_add_u32 s40, s94, 114688
    s_and_b32 s40, s40, 0x1c000
    buffer_load_dwordx4 v[176:179], v4, s[20:23], s40 offen offset:0 nt
    s_waitcnt vmcnt(7)
    s_add_u32 s40, s94, 98304
    s_and_b32 s40, s40, 0x1c000
    buffer_load_dwordx4 v[164:167], v4, s[20:23], s40 offen offset:1024 nt
    s_waitcnt vmcnt(7)
    s_add_u32 s40, s94, 114688
    s_and_b32 s40, s40, 0x1c000
    buffer_load_dwordx4 v[180:183], v4, s[20:23], s40 offen offset:1024 nt
    s_waitcnt vmcnt(7)
    s_add_u32 s40, s94, 98304
    s_and_b32 s40, s40, 0x1c000
    buffer_load_dwordx4 v[168:171], v4, s[20:23], s40 offen offset:2048 nt
    s_waitcnt vmcnt(7)
    buffer_load_dwordx4 v[172:175], v4, s[20:23], s40 offen offset:3072 nt
    s_waitcnt vmcnt(7)
    s_add_u32 s40, s94, 114688
    s_and_b32 s40, s40, 0x1c000
    buffer_load_dwordx4 v[184:187], v4, s[20:23], s40 offen offset:2048 nt
    v_perm_b32 v72, v132, v128, s44
    v_perm_b32 v73, v140, v136, s44
    v_perm_b32 v74, v148, v144, s44
    v_perm_b32 v75, v156, v152, s44
    v_perm_b32 v76, v132, v128, s45
    v_perm_b32 v77, v140, v136, s45
    v_perm_b32 v78, v148, v144, s45
    v_perm_b32 v79, v156, v152, s45
    v_mfma_f32_16x16x32_bf16 v[32:35], v[72:75], v[16:19], v[32:35]
    v_perm_b32 v80, v133, v129, s44
    v_perm_b32 v81, v141, v137, s44
    v_perm_b32 v82, v149, v145, s44
    v_perm_b32 v83, v157, v153, s44
    v_mfma_f32_16x16x32_bf16 v[36:39], v[76:79], v[16:19], v[36:39]
    v_perm_b32 v84, v133, v129, s45
    v_perm_b32 v85, v141, v137, s45
    v_perm_b32 v86, v149, v145, s45
    v_perm_b32 v87, v157, v153, s45
    v_mfma_f32_16x16x32_bf16 v[40:43], v[80:83], v[16:19], v[40:43]
    v_perm_b32 v88, v134, v130, s44
    v_perm_b32 v89, v142, v138, s44
    v_perm_b32 v90, v150, v146, s44
    v_perm_b32 v91, v158, v154, s44
    v_mfma_f32_16x16x32_bf16 v[44:47], v[84:87], v[16:19], v[44:47]
    v_perm_b32 v92, v134, v130, s45
    v_perm_b32 v93, v142, v138, s45
    v_perm_b32 v94, v150, v146, s45
    v_perm_b32 v95, v158, v154, s45
    v_mfma_f32_16x16x32_bf16 v[32:35], v[88:91], v[20:23], v[32:35]
    v_perm_b32 v96, v135, v131, s44
    v_perm_b32 v97, v143, v139, s44
    v_perm_b32 v98, v151, v147, s44
    v_perm_b32 v99, v159, v155, s44
    v_mfma_f32_16x16x32_bf16 v[36:39], v[92:95], v[20:23], v[36:39]
    v_perm_b32 v100, v135, v131, s45
    v_perm_b32 v101, v143, v139, s45
    v_perm_b32 v102, v151, v147, s45
    v_perm_b32 v103, v159, v155, s45
    v_mfma_f32_16x16x32_bf16 v[40:43], v[96:99], v[20:23], v[40:43]
    s_nop 0
    v_mfma_f32_16x16x32_bf16 v[44:47], v[100:103], v[20:23], v[44:47]
    v_mov_b32_dpp v16, v52 row_ror:8 row_mask:0xf bank_mask:0x3
    v_mov_b32_dpp v17, v53 row_ror:8 row_mask:0xf bank_mask:0x3
    v_mov_b32_dpp v18, v54 row_ror:8 row_mask:0xf bank_mask:0x3
    v_mov_b32_dpp v19, v55 row_ror:8 row_mask:0xf bank_mask:0x3
    v_mov_b32_dpp v20, v52 quad_perm:[0,1,2,3] row_mask:0xf bank_mask:0xc
    v_mov_b32_dpp v21, v53 quad_perm:[0,1,2,3] row_mask:0xf bank_mask:0xc
    v_mov_b32_dpp v22, v54 quad_perm:[0,1,2,3] row_mask:0xf bank_mask:0xc
    v_mov_b32_dpp v23, v55 quad_perm:[0,1,2,3] row_mask:0xf bank_mask:0xc
    s_waitcnt vmcnt(7)
    buffer_load_dwordx4 v[188:191], v4, s[20:23], s40 offen offset:3072 nt
L_chk_ml:
    s_waitcnt vmcnt(7)
    v_xor_b32 v108, s46, v108
    v_xor_b32 v110, s47, v110
    v_or_b32 v15, v108, v110
    v_and_b32 v15, 0xff, v15
    v_cmp_ne_u32 vcc, 0, v15
    s_nop 0
    s_cbranch_vccnz L_retry_ml
L_ok_ml:
    v_mov_b32 v104, v108
    s_nop 1
    v_max_f32_dpp v104, v104, v104 quad_perm:[1,0,3,2] row_mask:0xf bank_mask:0xf
    s_nop 1
    v_max_f32_dpp v104, v104, v104 quad_perm:[2,3,0,1] row_mask:0xf bank_mask:0xf
    s_nop 1
    v_max_f32_dpp v104, v104, v104 row_half_mirror row_mask:0xf bank_mask:0xf
    v_sub_f32 v108, v108, v104
    v_mul_f32 v108, 0x3fb8aa3b, v108
    v_exp_f32 v108, v108
    s_nop 0
    v_mul_f32 v109, v108, v109
    s_nop 1
    v_add_f32_dpp v109, v109, v109 quad_perm:[1,0,3,2] row_mask:0xf bank_mask:0xf
    s_nop 1
    v_add_f32_dpp v109, v109, v109 quad_perm:[2,3,0,1] row_mask:0xf bank_mask:0xf
    s_nop 1
    v_add_f32_dpp v109, v109, v109 row_half_mirror row_mask:0xf bank_mask:0xf
    v_rcp_f32 v109, v109
    s_nop 0
    v_mul_f32 v108, v108, v109
    ds_swizzle_b32 v60, v108 offset:0x18
    ds_swizzle_b32 v61, v108 offset:0x38
    ds_swizzle_b32 v62, v108 offset:0x58
    ds_swizzle_b32 v63, v108 offset:0x78
    ds_swizzle_b32 v64, v108 offset:0x98
    ds_swizzle_b32 v65, v108 offset:0xb8
    ds_swizzle_b32 v66, v108 offset:0xd8
    ds_swizzle_b32 v67, v108 offset:0xf8
    v_add_u32 v25, 4096, v2
    v_add_u32 v26, 8192, v2
    v_add_u32 v27, 12288, v2
    v_add_u32 v28, 16384, v2
    v_add_u32 v29, 20480, v2
    v_add_u32 v30, 24576, v2
    s_movk_i32 s15, 0xff
    s_xor_b32 s41, s46, 0x80
    s_xor_b32 s96, s47, 0x80
    s_waitcnt vmcnt(6)
    buffer_load_dwordx4 v[192:195], v7, s[28:31], 0 offen offset:0 nt
    s_waitcnt vmcnt(6)
    s_movk_i32 s40, 8192
    buffer_load_dwordx4 v[208:211], v7, s[28:31], s40 offen offset:0 nt
    v_perm_b32 v72, v164, v160, s44
    v_perm_b32 v76, v164, v160, s45
    v_perm_b32 v80, v165, v161, s44
    v_perm_b32 v84, v165, v161, s45
    v_perm_b32 v88, v166, v162, s44
    v_perm_b32 v92, v166, v162, s45
    v_perm_b32 v96, v167, v163, s44
    v_perm_b32 v100, v167, v163, s45
    s_waitcnt vmcnt(6)
    s_movk_i32 s40, 16384
    buffer_load_dwordx4 v[196:199], v7, s[28:31], s40 offen offset:0 nt
    v_perm_b32 v74, v180, v176, s44
    v_perm_b32 v78, v180, v176, s45
    v_perm_b32 v82, v181, v177, s44
    v_perm_b32 v86, v181, v177, s45
    v_perm_b32 v90, v182, v178, s44
    v_perm_b32 v94, v182, v178, s45
    v_perm_b32 v98, v183, v179, s44
    v_perm_b32 v102, v183, v179, s45
    s_waitcnt vmcnt(6)
    s_movk_i32 s40, 24576
    buffer_load_dwordx4 v[212:215], v7, s[28:31], s40 offen offset:0 nt
    s_waitcnt vmcnt(6)
    v_perm_b32 v73, v172, v168, s44
    v_perm_b32 v77, v172, v168, s45
    v_perm_b32 v81, v173, v169, s44
    v_perm_b32 v85, v173, v169, s45
    v_perm_b32 v89, v174, v170, s44
    v_perm_b32 v93, v174, v170, s45
    v_perm_b32 v97, v175, v171, s44
    v_perm_b32 v101, v175, v171, s45
    s_waitcnt vmcnt(4)
    v_perm_b32 v75, v188, v184, s44
    v_perm_b32 v91, v190, v186, s44
    v_perm_b32 v79, v188, v184, s45
    v_mfma_f32_16x16x32_bf16 v[32:35], v[72:75], v[16:19], v[32:35]
    v_perm_b32 v95, v190, v186, s45
    v_mfma_f32_16x16x32_bf16 v[32:35], v[88:91], v[20:23], v[32:35]
    v_perm_b32 v83, v189, v185, s44
    v_mfma_f32_16x16x32_bf16 v[36:39], v[76:79], v[16:19], v[36:39]
    v_perm_b32 v99, v191, v187, s44
    v_mfma_f32_16x16x32_bf16 v[36:39], v[92:95], v[20:23], v[36:39]
    v_perm_b32 v87, v189, v185, s45
    v_mfma_f32_16x16x32_bf16 v[40:43], v[80:83], v[16:19], v[40:43]
    v_perm_b32 v103, v191, v187, s45
    v_mfma_f32_16x16x32_bf16 v[40:43], v[96:99], v[20:23], v[40:43]
    v_mfma_f32_16x16x32_bf16 v[44:47], v[84:87], v[16:19], v[44:47]
    ds_write_b128 v9, v[32:35] offset:0
    v_mfma_f32_16x16x32_bf16 v[44:47], v[100:103], v[20:23], v[44:47]
    s_nop 0
    ds_write_b128 v9, v[36:39] offset:1088
    s_nop 2
    ds_write_b128 v9, v[40:43] offset:2176
    s_nop 1
    ds_write_b128 v9, v[44:47] offset:3264
    s_waitcnt lgkmcnt(0)
    s_barrier
    ds_read_b128 v[104:107], v10 offset:0
    ds_read_b128 v[108:111], v10 offset:4352
    ds_read_b128 v[112:115], v10 offset:8704
    ds_read_b128 v[116:119], v10 offset:13056
    s_waitcnt lgkmcnt(3)
    v_pk_mul_f32 v[104:105], v[104:105], v[68:69] op_sel:[0,0] op_sel_hi:[1,0]
    v_pk_mul_f32 v[106:107], v[106:107], v[68:69] op_sel:[0,0] op_sel_hi:[1,0]
    s_waitcnt lgkmcnt(2)
    v_pk_fma_f32 v[104:105], v[108:109], v[68:69], v[104:105] op_sel:[0,1,0] op_sel_hi:[1,1,1]
    v_pk_fma_f32 v[106:107], v[110:111], v[68:69], v[106:107] op_sel:[0,1,0] op_sel_hi:[1,1,1]
    s_waitcnt lgkmcnt(1)
    v_pk_fma_f32 v[104:105], v[112:113], v[70:71], v[104:105] op_sel:[0,0,0] op_sel_hi:[1,0,1]
    v_pk_fma_f32 v[106:107], v[114:115], v[70:71], v[106:107] op_sel:[0,0,0] op_sel_hi:[1,0,1]
    s_waitcnt lgkmcnt(0)
    v_pk_fma_f32 v[104:105], v[116:117], v[70:71], v[104:105] op_sel:[0,1,0] op_sel_hi:[1,1,1]
    v_pk_fma_f32 v[106:107], v[118:119], v[70:71], v[106:107] op_sel:[0,1,0] op_sel_hi:[1,1,1]
    buffer_load_dwordx4 v[128:131], v2, s[32:35], s97 offen offset:0 sc1
    buffer_load_dwordx4 v[132:135], v25, s[32:35], s97 offen offset:0 sc1
    buffer_load_dwordx4 v[136:139], v26, s[32:35], s97 offen offset:0 sc1
    buffer_load_dwordx4 v[140:143], v27, s[32:35], s97 offen offset:0 sc1
    buffer_load_dwordx4 v[144:147], v28, s[32:35], s97 offen offset:0 sc1
    buffer_load_dwordx4 v[148:151], v29, s[32:35], s97 offen offset:0 sc1
    buffer_load_dwordx4 v[152:155], v30, s[32:35], s97 offen offset:0 sc1
    v_pk_mul_f32 v[112:113], v[104:105], v[66:67] op_sel:[0,1] op_sel_hi:[1,1]
    v_pk_mul_f32 v[114:115], v[106:107], v[66:67] op_sel:[0,1] op_sel_hi:[1,1]
    s_waitcnt vmcnt(6)
    v_xor_b32 v128, s12, v128
    v_xor_b32 v130, s13, v130
    v_bitop3_b32 v15, v128, v130, s15 bitop3:0xa8
    v_cmp_ne_u32 s[8:9], 0, v15
    s_waitcnt vmcnt(5)
    v_xor_b32 v132, s12, v132
    v_xor_b32 v134, s13, v134
    v_bitop3_b32 v15, v132, v134, s15 bitop3:0xa8
    v_cmp_ne_u32 s[10:11], 0, v15
    s_waitcnt vmcnt(4)
    v_xor_b32 v136, s12, v136
    v_xor_b32 v138, s13, v138
    v_bitop3_b32 v15, v136, v138, s15 bitop3:0xa8
    v_cmp_ne_u32 s[16:17], 0, v15
    s_waitcnt vmcnt(3)
    v_xor_b32 v140, s12, v140
    v_xor_b32 v142, s13, v142
    v_bitop3_b32 v15, v140, v142, s15 bitop3:0xa8
    v_cmp_ne_u32 s[18:19], 0, v15
    s_waitcnt vmcnt(2)
    v_xor_b32 v144, s12, v144
    v_xor_b32 v146, s13, v146
    v_bitop3_b32 v15, v144, v146, s15 bitop3:0xa8
    v_cmp_ne_u32 s[20:21], 0, v15
    s_waitcnt vmcnt(1)
    v_xor_b32 v148, s12, v148
    v_xor_b32 v150, s13, v150
    v_bitop3_b32 v15, v148, v150, s15 bitop3:0xa8
    v_cmp_ne_u32 s[22:23], 0, v15
    s_waitcnt vmcnt(0)
    v_xor_b32 v152, s12, v152
    v_xor_b32 v154, s13, v154
    v_bitop3_b32 v15, v152, v154, s15 bitop3:0xa8
    v_cmp_ne_u32 vcc, 0, v15
    s_or_b64 s[58:59], s[8:9], s[10:11]
    s_or_b64 s[58:59], s[58:59], s[16:17]
    s_or_b64 s[58:59], s[58:59], s[18:19]
    s_or_b64 s[58:59], s[58:59], s[20:21]
    s_or_b64 s[58:59], s[58:59], s[22:23]
    s_or_b64 s[58:59], s[58:59], vcc
    s_cbranch_scc0 L_ok_o1
L_red:
    s_cmp_eq_u32 s48, 0
    s_cbranch_scc1 L_ok_o1
    s_sub_u32 s48, s48, 1
    s_cmp_eq_u64 s[8:9], 0
    s_cbranch_scc1 L_ra0
    buffer_load_dwordx4 v[128:131], v2, s[32:35], s97 offen offset:0 sc1
L_ra0:
    s_cmp_eq_u64 s[10:11], 0
    s_cbranch_scc1 L_ra1
    buffer_load_dwordx4 v[132:135], v25, s[32:35], s97 offen offset:0 sc1
L_ra1:
    s_cmp_eq_u64 s[16:17], 0
    s_cbranch_scc1 L_ra2
    buffer_load_dwordx4 v[136:139], v26, s[32:35], s97 offen offset:0 sc1
L_ra2:
    s_cmp_eq_u64 s[18:19], 0
    s_cbranch_scc1 L_ra3
    buffer_load_dwordx4 v[140:143], v27, s[32:35], s97 offen offset:0 sc1
L_ra3:
    s_cmp_eq_u64 s[20:21], 0
    s_cbranch_scc1 L_ra4
    buffer_load_dwordx4 v[144:147], v28, s[32:35], s97 offen offset:0 sc1
L_ra4:
    s_cmp_eq_u64 s[22:23], 0
    s_cbranch_scc1 L_ra5
    buffer_load_dwordx4 v[148:151], v29, s[32:35], s97 offen offset:0 sc1
L_ra5:
    s_cmp_eq_u64 vcc, 0
    s_cbranch_scc1 L_ra6
    buffer_load_dwordx4 v[152:155], v30, s[32:35], s97 offen offset:0 sc1
L_ra6:
    s_waitcnt vmcnt(0)
    s_cmp_eq_u64 s[8:9], 0
    s_cbranch_scc1 L_rb0
    v_xor_b32 v128, s12, v128
    v_xor_b32 v130, s13, v130
    v_bitop3_b32 v15, v128, v130, s15 bitop3:0xa8
    v_cmp_ne_u32 s[8:9], 0, v15
L_rb0:
    s_cmp_eq_u64 s[10:11], 0
    s_cbranch_scc1 L_rb1
    v_xor_b32 v132, s12, v132
    v_xor_b32 v134, s13, v134
    v_bitop3_b32 v15, v132, v134, s15 bitop3:0xa8
    v_cmp_ne_u32 s[10:11], 0, v15
L_rb1:
    s_cmp_eq_u64 s[16:17], 0
    s_cbranch_scc1 L_rb2
    v_xor_b32 v136, s12, v136
    v_xor_b32 v138, s13, v138
    v_bitop3_b32 v15, v136, v138, s15 bitop3:0xa8
    v_cmp_ne_u32 s[16:17], 0, v15
L_rb2:
    s_cmp_eq_u64 s[18:19], 0
    s_cbranch_scc1 L_rb3
    v_xor_b32 v140, s12, v140
    v_xor_b32 v142, s13, v142
    v_bitop3_b32 v15, v140, v142, s15 bitop3:0xa8
    v_cmp_ne_u32 s[18:19], 0, v15
L_rb3:
    s_cmp_eq_u64 s[20:21], 0
    s_cbranch_scc1 L_rb4
    v_xor_b32 v144, s12, v144
    v_xor_b32 v146, s13, v146
    v_bitop3_b32 v15, v144, v146, s15 bitop3:0xa8
    v_cmp_ne_u32 s[20:21], 0, v15
L_rb4:
    s_cmp_eq_u64 s[22:23], 0
    s_cbranch_scc1 L_rb5
    v_xor_b32 v148, s12, v148
    v_xor_b32 v150, s13, v150
    v_bitop3_b32 v15, v148, v150, s15 bitop3:0xa8
    v_cmp_ne_u32 s[22:23], 0, v15
L_rb5:
    s_cmp_eq_u64 vcc, 0
    s_cbranch_scc1 L_rb6
    v_xor_b32 v152, s12, v152
    v_xor_b32 v154, s13, v154
    v_bitop3_b32 v15, v152, v154, s15 bitop3:0xa8
    v_cmp_ne_u32 vcc, 0, v15
L_rb6:
    s_or_b64 s[58:59], s[8:9], s[10:11]
    s_or_b64 s[58:59], s[58:59], s[16:17]
    s_or_b64 s[58:59], s[58:59], s[18:19]
    s_or_b64 s[58:59], s[58:59], s[20:21]
    s_or_b64 s[58:59], s[58:59], s[22:23]
    s_or_b64 s[58:59], s[58:59], vcc
    s_cbranch_scc1 L_red
L_ok_o1:
    v_pk_mul_f32 v[116:117], v[128:129], v[60:61] op_sel:[0,0] op_sel_hi:[1,0]
    v_pk_mul_f32 v[118:119], v[130:131], v[60:61] op_sel:[0,0] op_sel_hi:[1,0]
    v_pk_fma_f32 v[112:113], v[132:133], v[60:61], v[112:113] op_sel:[0,1,0] op_sel_hi:[1,1,1]
    v_pk_fma_f32 v[114:115], v[134:135], v[60:61], v[114:115] op_sel:[0,1,0] op_sel_hi:[1,1,1]
    v_pk_fma_f32 v[116:117], v[136:137], v[62:63], v[116:117] op_sel:[0,0,0] op_sel_hi:[1,0,1]
    v_pk_fma_f32 v[118:119], v[138:139], v[62:63], v[118:119] op_sel:[0,0,0] op_sel_hi:[1,0,1]
    v_pk_fma_f32 v[112:113], v[140:141], v[62:63], v[112:113] op_sel:[0,1,0] op_sel_hi:[1,1,1]
    v_pk_fma_f32 v[114:115], v[142:143], v[62:63], v[114:115] op_sel:[0,1,0] op_sel_hi:[1,1,1]
    v_pk_fma_f32 v[116:117], v[144:145], v[64:65], v[116:117] op_sel:[0,0,0] op_sel_hi:[1,0,1]
    v_pk_fma_f32 v[118:119], v[146:147], v[64:65], v[118:119] op_sel:[0,0,0] op_sel_hi:[1,0,1]
    v_pk_fma_f32 v[112:113], v[148:149], v[64:65], v[112:113] op_sel:[0,1,0] op_sel_hi:[1,1,1]
    v_pk_fma_f32 v[114:115], v[150:151], v[64:65], v[114:115] op_sel:[0,1,0] op_sel_hi:[1,1,1]
    v_pk_fma_f32 v[116:117], v[152:153], v[66:67], v[116:117] op_sel:[0,0,0] op_sel_hi:[1,0,1]
    v_pk_fma_f32 v[118:119], v[154:155], v[66:67], v[118:119] op_sel:[0,0,0] op_sel_hi:[1,0,1]
    v_pk_add_f32 v[112:113], v[112:113], v[116:117]
    v_pk_add_f32 v[114:115], v[114:115], v[118:119]
    v_cvt_pk_bf16_f32 v113, v112, v113
    v_cvt_pk_bf16_f32 v115, v114, v115
    v_lshl_or_b32 v112, v113, 16, s41
    v_lshl_or_b32 v114, v115, 16, s96
    s_barrier
    buffer_store_dwordx4 v[112:115], v2, s[32:35], s54 offen sc1
    s_mov_b32 s43, s97
    s_cmp_eq_u32 s57, 0
    s_cbranch_scc1 L_far_o2b
    buffer_store_dwordx4 v[112:115], v127, s[32:35], s43 offen
L_back_o2b:
    s_mov_b32 s43, s42
    s_mov_b32 s40, 32768
    buffer_load_dwordx4 v[200:203], v7, s[28:31], s40 offen offset:0 nt
    s_mov_b32 s40, 40960
    buffer_load_dwordx4 v[216:219], v7, s[28:31], s40 offen offset:0 nt
    s_mov_b32 s40, 49152
    buffer_load_dwordx4 v[204:207], v7, s[28:31], s40 offen offset:0 nt
    s_mov_b32 s40, 57344
    buffer_load_dwordx4 v[220:223], v7, s[28:31], s40 offen offset:0 nt
    buffer_load_dwordx4 v[104:107], v124, s[32:35], s6 offen offset:0 sc1
    s_add_u32 s12, s46, 64
    s_and_b32 s12, s12, 0xff
    s_add_u32 s13, s47, 64
    s_and_b32 s13, s13, 0xff
    v_mov_b32 v48, 0
    v_mov_b32 v49, 0
    v_mov_b32 v50, 0
    v_mov_b32 v51, 0
    v_mov_b32 v52, 0
    v_mov_b32 v53, 0
    v_mov_b32 v54, 0
    v_mov_b32 v55, 0
    v_mov_b32 v56, 0
    v_mov_b32 v57, 0
    v_mov_b32 v58, 0
    v_mov_b32 v59, 0
    v_mov_b32 v60, 0
    v_mov_b32 v61, 0
    v_mov_b32 v62, 0
    v_mov_b32 v63, 0
    v_perm_b32 v72, v196, v192, s44
    v_perm_b32 v76, v196, v192, s45
    v_perm_b32 v80, v197, v193, s44
    v_perm_b32 v84, v197, v193, s45
    v_perm_b32 v88, v198, v194, s44
    v_perm_b32 v92, v198, v194, s45
    v_perm_b32 v96, v199, v195, s44
    v_perm_b32 v100, v199, v195, s45
    v_perm_b32 v74, v212, v208, s44
    v_perm_b32 v78, v212, v208, s45
    v_perm_b32 v82, v213, v209, s44
    v_perm_b32 v86, v213, v209, s45
    v_perm_b32 v90, v214, v210, s44
    v_perm_b32 v94, v214, v210, s45
    v_perm_b32 v98, v215, v211, s44
    v_perm_b32 v102, v215, v211, s45
    s_waitcnt vmcnt(2)
    v_perm_b32 v73, v204, v200, s44
    v_perm_b32 v77, v204, v200, s45
    v_perm_b32 v81, v205, v201, s44
    v_perm_b32 v85, v205, v201, s45
    v_perm_b32 v89, v206, v202, s44
    v_perm_b32 v93, v206, v202, s45
    v_perm_b32 v97, v207, v203, s44
    v_perm_b32 v101, v207, v203, s45
    s_waitcnt vmcnt(1)
    v_perm_b32 v75, v220, v216, s44
    v_perm_b32 v79, v220, v216, s45
    v_perm_b32 v83, v221, v217, s44
    v_perm_b32 v87, v221, v217, s45
    v_perm_b32 v91, v222, v218, s44
    v_perm_b32 v95, v222, v218, s45
    v_perm_b32 v99, v223, v219, s44
    v_perm_b32 v103, v223, v219, s45
    s_branch L_join
L_retry_xt:
    s_sub_u32 s49, s49, 1
    s_cbranch_scc1 L_ok_xt
    buffer_load_dword v14, v7, s[32:35], s41 offen sc1
    s_waitcnt vmcnt(0)
    s_branch L_chk_xt
L_far_qst:
    buffer_store_dwordx4 v[104:107], v127, s[32:35], s43 offen sc1
    s_branch L_back_qst
L_retry_q1:
    s_cmp_eq_u32 s48, 0
    s_cbranch_scc1 L_ok_q1
    s_sub_u32 s48, s48, 1
    buffer_load_dwordx4 v[108:111], v2, s[32:35], s41 offen offset:0 sc1
    s_waitcnt vmcnt(0)
    s_branch L_chk_q1
L_far_q2st:
    buffer_store_dwordx4 v[104:107], v126, s[32:35], s43 offen sc1
    s_branch L_back_q2st
L_far_akst:
    buffer_store_dwordx4 v[116:119], v2, s[32:35], s43 offen sc1
    s_branch L_back_akst
L_retry_ak:
    s_cmp_eq_u32 s48, 0
    s_cbranch_scc1 L_ok_ak
    s_sub_u32 s48, s48, 1
    buffer_load_dwordx4 v[112:115], v120, s[32:35], s96 offen offset:0 sc1
    s_waitcnt vmcnt(0)
    s_branch L_chk_ak
L_far_tst:
    buffer_store_dwordx4 v[64:67], v127, s[32:35], s43 offen sc1
    s_branch L_back_tst
L_retry_q:
    s_cmp_eq_u32 s48, 0
    s_cbranch_scc1 L_ok_q
    s_sub_u32 s48, s48, 1
    buffer_load_dwordx4 v[108:111], v8, s[32:35], s41 offen offset:0 sc1
    s_waitcnt vmcnt(0)
    s_branch L_chk_q
L_far_mlst:
    buffer_store_dwordx4 v[72:75], v7, s[32:35], s43 offen sc1
    s_branch L_back_mlst
L_retry_gu:
    s_cmp_eq_u32 s48, 0
    s_cbranch_scc1 L_ok_gu
    s_sub_u32 s48, s48, 1
    buffer_load_dwordx4 v[112:115], v2, s[32:35], s42 offen offset:0 sc1
    s_waitcnt vmcnt(0)
    s_branch L_chk_gu
L_far_ost:
    buffer_store_dwordx4 v[104:107], v2, s[32:35], s43 offen sc1
    s_branch L_back_ost
L_retry_h:
    s_cmp_eq_u32 s48, 0
    s_cbranch_scc1 L_ok_h
    s_sub_u32 s48, s48, 1
    buffer_load_dwordx4 v[128:131], v8, s[32:35], s96 offen offset:0 sc1
    s_waitcnt vmcnt(0)
    s_branch L_chk_h
L_retry_ml:
    s_cmp_eq_u32 s48, 0
    s_cbranch_scc1 L_ok_ml
    s_sub_u32 s48, s48, 1
    buffer_load_dwordx4 v[108:111], v8, s[32:35], s41 offen offset:0 sc1
    s_waitcnt vmcnt(0)
    s_branch L_chk_ml
L_far_o2b:
    buffer_store_dwordx4 v[112:115], v127, s[32:35], s43 offen sc1
    s_branch L_back_o2b
L_far_fst:
    buffer_store_dwordx4 v[32:35], v2, s[32:35], s43 offen sc1
    s_branch L_back_fst
L_end:
    s_endpgm
.section .rodata,"a"
.p2align 6
.amdhsa_kernel parallel_sum__gqa_block_cached__glu_gated_bilinear__decode_kernel
  .amdhsa_next_free_vgpr 384
  .amdhsa_next_free_sgpr 102
  .amdhsa_accum_offset 256
  .amdhsa_group_segment_fixed_size 0
  .amdhsa_kernarg_size 96
  .amdhsa_user_sgpr_count 2
  .amdhsa_user_sgpr_kernarg_segment_ptr 1
  .amdhsa_system_sgpr_workgroup_id_x 1
  .amdhsa_float_denorm_mode_32 3
.end_amdhsa_kernel
```
